```python
import torch

def _softmax(x, axis=-1):
    return torch.softmax(x, dim=axis)
def _gelu(x):
    return torch.nn.functional.gelu(x, approximate="tanh")
def _silu(x):
    return torch.nn.functional.silu(x)
def _sigmoid(x):
    return torch.sigmoid(x)
def _layernorm(x, axis=-1, eps=1e-5):
    m = x.mean(dim=axis, keepdim=True)
    v = x.var(dim=axis, keepdim=True, unbiased=False)
    return (x - m) / torch.sqrt(v + eps)
def _scatter_add(tgt, idx, src, axis=0):
    return tgt.clone().index_add_(axis, idx, src)
def _segment_sum(src, seg, n):
    out = torch.zeros((n,) + src.shape[1:], dtype=src.dtype)
    return out.index_add_(0, seg, src)
def _pad(x, pw):
    flat = tuple(v for pair in reversed(pw) for v in pair)
    return torch.nn.functional.pad(x, flat)

kernel_name = 'parallel_sum__sliding_local_dilated__mixer_token_mlp__prompt'

def setup_inputs():

    _w = (lambda a: (lambda t: t.to(torch.bfloat16) if t.is_floating_point() else t)(torch.as_tensor(a)))
    def _A_setup():
        B, S, D = 1, 2048, 512
        return {
            "x": _w((lambda *s: torch.randn(*s, dtype=torch.bfloat16) * 0.05)(B, S, D)),
            "wqkv": _w((lambda *s: torch.randn(*s, dtype=torch.bfloat16) * 0.05)(D, 3 * D)),
            "wo": _w((lambda *s: torch.randn(*s, dtype=torch.bfloat16) * 0.05)(D, D)),
        }
    _A_in = _A_setup()

    def _B_setup():
        B, S, D, F = 1, 2048, 512, 1376
        return {
            "x": _w((lambda *s: torch.randn(*s, dtype=torch.bfloat16) * 0.05)(B, S, D)),
            "w1": _w((lambda *s: torch.randn(*s, dtype=torch.bfloat16) * 1.6)(S, F) * (S ** -0.5)),
            "b1": _w((lambda *s: torch.randn(*s, dtype=torch.bfloat16) * 12.8)(F) * 0.02),
            "w2": _w((lambda *s: torch.randn(*s, dtype=torch.bfloat16) * 0.8)(F, S) * (F ** -0.5)),
            "b2": _w((lambda *s: torch.randn(*s, dtype=torch.bfloat16) * 12.8)(S) * 0.02),
        }
    _B_in = _B_setup()

    return {
        "A_x": _A_in["x"],
        "A_wqkv": _A_in["wqkv"],
        "A_wo": _A_in["wo"],
        "B_x": _B_in["x"],
        "B_w1": _B_in["w1"],
        "B_b1": _B_in["b1"],
        "B_w2": _B_in["w2"],
        "B_b2": _B_in["b2"],
    }

def reference(A_x, A_wqkv, A_wo, B_x, B_w1, B_b1, B_w2, B_b2):
    def _A_ref(x, wqkv, wo):
        B, S, D = x.shape
        H = 32; Dh = D // H
        W, dil = 8, 2
        qkv = (lambda x, *d: x.permute(*d))((x @ wqkv).reshape(B, S, 3, H, Dh), 2, 0, 3, 1, 4)
        q, k, v = qkv[0], qkv[1], qkv[2]
        scale = Dh ** -0.5
        pos = torch.arange(S)
        off = torch.arange(W) * dil
        idx = pos[:, None] - off[None, :]
        mask = idx >= 0
        idx_c = torch.where(mask, idx, 0).reshape(-1)
        kg = k[:, :, idx_c, :].reshape(B, H, S, W, Dh)
        vg = v[:, :, idx_c, :].reshape(B, H, S, W, Dh)
        logits = torch.einsum("bhsd,bhswd->bhsw", q, kg) * scale
        logits = torch.where(mask[None, None, :, :], logits, -1e9)
        attn = _softmax(logits, axis=-1)
        o = torch.einsum("bhsw,bhswd->bhsd", attn, vg)
        return (lambda x, *d: x.permute(*d))(o, 0, 2, 1, 3).reshape(B, S, D) @ wo

    def _B_ref(x, w1, b1, w2, b2):
        B, S, D = x.shape
        h = _layernorm(x, axis=-1)
        u = torch.einsum("bsd,sf->bdf", h, w1) + b1
        u = _gelu(u)
        y = torch.einsum("bdf,fs->bds", u, w2) + b2
        return (lambda x, *d: x.permute(*d))(y, 0, 2, 1)

    x = A_x
    xn = _layernorm(x, axis=-1)
    return x + _A_ref(xn, A_wqkv, A_wo) + _B_ref(xn, B_w1, B_b1, B_w2, B_b2)
```

```asm
; @launch grid=(256,1,1) block=(256,1,1) lds=163840
.amdgcn_target "amdgcn-amd-amdhsa--gfx950"
.text
.globl parallel_sum__sliding_local_dilated__mixer_token_mlp__prompt_kernel
.p2align 8
.type parallel_sum__sliding_local_dilated__mixer_token_mlp__prompt_kernel,@function
parallel_sum__sliding_local_dilated__mixer_token_mlp__prompt_kernel:
    s_cmp_ge_u32 s2, 256
    s_cbranch_scc1 L_exit
    s_load_dwordx16 s[4:19], s[0:1], 0
    s_load_dwordx4 s[20:23], s[0:1], 64
    s_load_dwordx2 s[24:25], s[0:1], 80
    s_memrealtime s[74:75]
    v_and_b32 v1, 63, v0
    v_lshrrev_b32 v2, 6, v0
    v_lshlrev_b32 v11, 4, v1
    v_readfirstlane_b32 s26, v2
    s_and_b32 s48, s2, 7
    s_lshr_b32 s49, s2, 3
    s_and_b32 s78, s48, 3
    s_lshl_b32 s78, s78, 3
    s_and_b32 s50, s49, 7
    s_add_u32 s78, s78, s50
    s_lshr_b32 s79, s48, 2
    s_lshl_b32 s79, s79, 2
    s_lshr_b32 s50, s49, 3
    s_add_u32 s79, s79, s50
    s_waitcnt lgkmcnt(0)
    s_mov_b32 s28, s24
    s_and_b32 s29, s25, 0xffff
    s_mov_b32 s30, 0x10000000
    s_mov_b32 s31, 0x20000
    s_mov_b32 s44, s22
    s_and_b32 s45, s23, 0xffff
    s_mov_b32 s46, 0x100
    s_mov_b32 s47, 0x20000
    s_cmp_ge_u32 s49, 8
    s_cbranch_scc1 Lcp_1
    s_cmp_lg_u32 s26, 3
    s_cbranch_scc1 Lcp_1
    s_getpc_b64 s[52:53]
Lpc_here:
    s_sub_u32 s52, s52, Lpc_here-parallel_sum__sliding_local_dilated__mixer_token_mlp__prompt_kernel
    s_subb_u32 s53, s53, 0
    s_lshl_b32 s51, s49, 13
    v_lshlrev_b32 v2, 7, v1
    v_add_u32 v2, s51, v2
    v_min_u32 v2, Lcode_end-parallel_sum__sliding_local_dilated__mixer_token_mlp__prompt_kernel-4, v2
    global_load_dword v26, v2, s[52:53]
Lcp_1:
    s_or_b32 s50, s2, s26
    s_cmp_lg_u32 s50, 0
    s_cbranch_scc1 Ln_2
    s_or_b32 s74, s74, 1
    v_mov_b32 v4, s74
    v_mov_b32 v5, s75
    v_mov_b32 v2, 0
    s_mov_b64 exec, 1
    buffer_store_dwordx2 v[4:5], v2, s[44:47], 0 offen sc1
    s_mov_b64 exec, -1
Ln_2:
    s_cmp_ge_u32 s48, 6
    s_cbranch_scc1 L_qrole
    s_cmp_ge_u32 s48, 4
    s_cselect_b32 s50, 24, 32
    s_cmp_ge_u32 s49, s50
    s_cbranch_scc1 L_qrole
    s_and_b32 s77, s48, 1
    s_lshl_b32 s77, s77, 2
    s_and_b32 s51, s49, 3
    s_add_u32 s77, s77, s51
    s_lshr_b32 s76, s48, 1
    s_lshl_b32 s76, s76, 3
    s_lshr_b32 s51, s49, 2
    s_add_u32 s76, s76, s51
    s_mul_i32 s73, s49, 6
    s_add_u32 s73, s73, s48
    s_cmp_ge_u32 s73, 128
    s_cbranch_scc1 L_noln
    s_mov_b32 s40, s4
    s_and_b32 s41, s5, 0xffff
    s_mov_b32 s42, 0x200000
    s_mov_b32 s43, 0x20000
    v_lshrrev_b32 v2, 4, v0
    v_and_b32 v3, 15, v0
    v_lshlrev_b32 v4, 10, v2
    v_lshl_add_u32 v4, v3, 4, v4
    s_lshl_b32 s48, s73, 14
    buffer_load_dwordx4 v[200:203], v4, s[40:43], s48 offen offset:0
    buffer_load_dwordx4 v[204:207], v4, s[40:43], s48 offen offset:256
    buffer_load_dwordx4 v[208:211], v4, s[40:43], s48 offen offset:512
    buffer_load_dwordx4 v[212:215], v4, s[40:43], s48 offen offset:768
    s_mov_b32 s32, s12
    s_and_b32 s33, s13, 0xffff
    s_mov_b32 s34, 0x560000
    s_mov_b32 s35, 0x20000
    s_lshr_b32 s56, s26, 1
    s_and_b32 s57, s26, 1
    s_mul_i32 s58, s26, 24576
    v_lshrrev_b32 v2, 3, v1
    v_and_b32 v3, 7, v1
    v_bfe_u32 v4, v1, 4, 1
    v_lshlrev_b32 v4, 2, v4
    v_xor_b32 v3, v3, v4
    s_mov_b32 s48, 2752
    v_mul_lo_u32 v2, v2, s48
    v_lshl_add_u32 v10, v3, 4, v2
    v_bfe_u32 v2, v1, 2, 2
    v_lshrrev_b32 v3, 5, v1
    v_bfe_u32 v4, v1, 4, 1
    v_and_b32 v5, 3, v1
    v_lshl_add_u32 v6, v3, 3, v2
    v_lshlrev_b32 v6, 7, v6
    v_lshrrev_b32 v7, 1, v2
    v_xor_b32 v7, s56, v7
    v_lshl_add_u32 v6, v7, 6, v6
    v_lshl_add_u32 v6, v4, 5, v6
    v_lshrrev_b32 v7, 1, v5
    v_lshl_add_u32 v6, v7, 4, v6
    v_and_b32 v7, 1, v5
    v_lshl_add_u32 v6, v7, 3, v6
    v_add_u32 v12, s58, v6
    v_xor_b32 v13, 64, v12
    s_lshl_b32 s60, s76, 7
    s_mul_i32 s48, s26, 1409024
    s_add_u32 s60, s60, s48
    s_add_u32 s61, s60, 22016
    s_lshl_b32 s62, s77, 1
    s_add_u32 s62, s62, s57
    s_xor_b32 s63, s62, 1
    s_lshl_b32 s62, s62, 17
    s_lshl_b32 s63, s63, 17
    s_lshl_b32 s48, s26, 15
    s_add_u32 s62, s62, s48
    s_add_u32 s63, s63, s48
    s_and_b32 s48, s76, 7
    s_mul_i32 s48, s48, 5
    s_and_b32 s65, s77, 3
    s_lshl_b32 s65, s65, 3
    s_add_u32 s65, s65, s48
    s_lshr_b32 s48, s77, 2
    s_lshl_b32 s48, s48, 2
    s_add_u32 s65, s65, s48
    s_and_b32 s59, s65, 31
    s_mul_i32 s61, s59, 44032
    s_add_u32 s61, s61, s60
    s_add_u32 s55, s60, 1409024
    v_add_u32 v9, 22016, v10
    s_lshl_b32 s59, s59, 10
    v_add_u32 v16, s62, v11
    v_add_u32 v17, s63, v11
    s_mov_b32 s36, s14
    s_and_b32 s37, s15, 0xffff
    s_mov_b32 s38, 0xac0
    s_mov_b32 s39, 0x20000
    v_lshrrev_b32 v2, 5, v1
    v_lshlrev_b32 v2, 3, v2
    s_lshl_b32 s64, s76, 7
    s_lshl_b32 s48, s56, 6
    s_add_u32 s64, s64, s48
    buffer_load_dwordx2 v[40:41], v2, s[36:39], s64 offen offset:0
    buffer_load_dwordx2 v[42:43], v2, s[36:39], s64 offen offset:16
    buffer_load_dwordx2 v[44:45], v2, s[36:39], s64 offen offset:32
    buffer_load_dwordx2 v[46:47], v2, s[36:39], s64 offen offset:48
    s_add_u32 m0, s58, 0
    s_add_u32 s48, s61, 44032
    buffer_load_dwordx4 v10, s[32:35], s61 offen lds
    s_add_u32 m0, s58, 1024
    s_cmp_eq_u32 s48, s55
    buffer_load_dwordx4 v9, s[32:35], s61 offen lds
    s_cselect_b32 s61, s60, s48
    s_add_u32 m0, s58, 2048
    s_add_u32 s48, s61, 44032
    buffer_load_dwordx4 v10, s[32:35], s61 offen lds
    s_add_u32 m0, s58, 3072
    s_cmp_eq_u32 s48, s55
    buffer_load_dwordx4 v9, s[32:35], s61 offen lds
    s_cselect_b32 s61, s60, s48
    s_add_u32 m0, s58, 4096
    s_add_u32 s48, s61, 44032
    buffer_load_dwordx4 v10, s[32:35], s61 offen lds
    s_add_u32 m0, s58, 5120
    s_cmp_eq_u32 s48, s55
    buffer_load_dwordx4 v9, s[32:35], s61 offen lds
    s_cselect_b32 s61, s60, s48
    s_add_u32 m0, s58, 6144
    s_add_u32 s48, s61, 44032
    buffer_load_dwordx4 v10, s[32:35], s61 offen lds
    s_add_u32 m0, s58, 7168
    s_cmp_eq_u32 s48, s55
    buffer_load_dwordx4 v9, s[32:35], s61 offen lds
    s_cselect_b32 s61, s60, s48
    v_lshrrev_b32 v2, 4, v0
    v_and_b32 v3, 15, v0
    v_mul_u32_u24 v5, 1088, v2
    v_lshl_add_u32 v5, v3, 4, v5
    v_add_u32 v5, 98304, v5
    v_lshrrev_b32 v6, 5, v1
    v_lshlrev_b32 v6, 3, v6
    v_bfe_u32 v7, v1, 2, 2
    v_add_u32 v6, v6, v7
    v_mul_u32_u24 v6, 1088, v6
    v_bfe_u32 v7, v1, 4, 1
    v_lshl_add_u32 v6, v7, 5, v6
    v_and_b32 v7, 3, v1
    v_lshl_add_u32 v6, v7, 3, v6
    s_lshl_b32 s49, s26, 8
    s_add_u32 s49, s49, 98304
    v_add_u32 v6, s49, v6
    s_waitcnt vmcnt(12)
    v_lshlrev_b32 v128, 16, v200
    v_and_b32 v129, 0xffff0000, v200
    v_lshlrev_b32 v130, 16, v201
    v_and_b32 v131, 0xffff0000, v201
    v_lshlrev_b32 v132, 16, v202
    v_and_b32 v133, 0xffff0000, v202
    v_lshlrev_b32 v134, 16, v203
    v_and_b32 v135, 0xffff0000, v203
    v_lshlrev_b32 v136, 16, v204
    v_and_b32 v137, 0xffff0000, v204
    v_lshlrev_b32 v138, 16, v205
    v_and_b32 v139, 0xffff0000, v205
    v_lshlrev_b32 v140, 16, v206
    v_and_b32 v141, 0xffff0000, v206
    v_lshlrev_b32 v142, 16, v207
    v_and_b32 v143, 0xffff0000, v207
    v_lshlrev_b32 v144, 16, v208
    v_and_b32 v145, 0xffff0000, v208
    v_lshlrev_b32 v146, 16, v209
    v_and_b32 v147, 0xffff0000, v209
    v_lshlrev_b32 v148, 16, v210
    v_and_b32 v149, 0xffff0000, v210
    v_lshlrev_b32 v150, 16, v211
    v_and_b32 v151, 0xffff0000, v211
    v_lshlrev_b32 v152, 16, v212
    v_and_b32 v153, 0xffff0000, v212
    v_lshlrev_b32 v154, 16, v213
    v_and_b32 v155, 0xffff0000, v213
    v_lshlrev_b32 v156, 16, v214
    v_and_b32 v157, 0xffff0000, v214
    v_lshlrev_b32 v158, 16, v215
    v_and_b32 v159, 0xffff0000, v215
    v_pk_add_f32 v[160:161], v[128:129], v[130:131]
    v_pk_add_f32 v[162:163], v[132:133], v[134:135]
    v_pk_add_f32 v[160:161], v[160:161], v[136:137]
    v_pk_add_f32 v[162:163], v[162:163], v[138:139]
    v_pk_add_f32 v[160:161], v[160:161], v[140:141]
    v_pk_add_f32 v[162:163], v[162:163], v[142:143]
    v_pk_add_f32 v[160:161], v[160:161], v[144:145]
    v_pk_add_f32 v[162:163], v[162:163], v[146:147]
    v_pk_add_f32 v[160:161], v[160:161], v[148:149]
    v_pk_add_f32 v[162:163], v[162:163], v[150:151]
    v_pk_add_f32 v[160:161], v[160:161], v[152:153]
    v_pk_add_f32 v[162:163], v[162:163], v[154:155]
    v_pk_add_f32 v[160:161], v[160:161], v[156:157]
    v_pk_add_f32 v[162:163], v[162:163], v[158:159]
    v_pk_add_f32 v[160:161], v[160:161], v[162:163]
    v_add_f32 v160, v160, v161
    s_nop 1
    v_add_f32_dpp v160, v160, v160 row_ror:8 row_mask:0xf bank_mask:0xf
    s_nop 1
    v_add_f32_dpp v160, v160, v160 row_ror:4 row_mask:0xf bank_mask:0xf
    s_nop 1
    v_add_f32_dpp v160, v160, v160 row_ror:2 row_mask:0xf bank_mask:0xf
    s_nop 1
    v_add_f32_dpp v160, v160, v160 row_ror:1 row_mask:0xf bank_mask:0xf
    v_mul_f32 v160, 0xbb000000, v160
    s_nop 0
    v_pk_add_f32 v[128:129], v[128:129], v[160:161] op_sel_hi:[1,0]
    v_pk_add_f32 v[130:131], v[130:131], v[160:161] op_sel_hi:[1,0]
    v_pk_add_f32 v[132:133], v[132:133], v[160:161] op_sel_hi:[1,0]
    v_pk_add_f32 v[134:135], v[134:135], v[160:161] op_sel_hi:[1,0]
    v_pk_add_f32 v[136:137], v[136:137], v[160:161] op_sel_hi:[1,0]
    v_pk_add_f32 v[138:139], v[138:139], v[160:161] op_sel_hi:[1,0]
    v_pk_add_f32 v[140:141], v[140:141], v[160:161] op_sel_hi:[1,0]
    v_pk_add_f32 v[142:143], v[142:143], v[160:161] op_sel_hi:[1,0]
    v_pk_add_f32 v[144:145], v[144:145], v[160:161] op_sel_hi:[1,0]
    v_pk_add_f32 v[146:147], v[146:147], v[160:161] op_sel_hi:[1,0]
    v_pk_add_f32 v[148:149], v[148:149], v[160:161] op_sel_hi:[1,0]
    v_pk_add_f32 v[150:151], v[150:151], v[160:161] op_sel_hi:[1,0]
    v_pk_add_f32 v[152:153], v[152:153], v[160:161] op_sel_hi:[1,0]
    v_pk_add_f32 v[154:155], v[154:155], v[160:161] op_sel_hi:[1,0]
    v_pk_add_f32 v[156:157], v[156:157], v[160:161] op_sel_hi:[1,0]
    v_pk_add_f32 v[158:159], v[158:159], v[160:161] op_sel_hi:[1,0]
    v_pk_mul_f32 v[164:165], v[128:129], v[128:129]
    v_pk_mul_f32 v[166:167], v[130:131], v[130:131]
    v_pk_fma_f32 v[164:165], v[132:133], v[132:133], v[164:165]
    v_pk_fma_f32 v[166:167], v[134:135], v[134:135], v[166:167]
    v_pk_fma_f32 v[164:165], v[136:137], v[136:137], v[164:165]
    v_pk_fma_f32 v[166:167], v[138:139], v[138:139], v[166:167]
    v_pk_fma_f32 v[164:165], v[140:141], v[140:141], v[164:165]
    v_pk_fma_f32 v[166:167], v[142:143], v[142:143], v[166:167]
    v_pk_fma_f32 v[164:165], v[144:145], v[144:145], v[164:165]
    v_pk_fma_f32 v[166:167], v[146:147], v[146:147], v[166:167]
    v_pk_fma_f32 v[164:165], v[148:149], v[148:149], v[164:165]
    v_pk_fma_f32 v[166:167], v[150:151], v[150:151], v[166:167]
    v_pk_fma_f32 v[164:165], v[152:153], v[152:153], v[164:165]
    v_pk_fma_f32 v[166:167], v[154:155], v[154:155], v[166:167]
    v_pk_fma_f32 v[164:165], v[156:157], v[156:157], v[164:165]
    v_pk_fma_f32 v[166:167], v[158:159], v[158:159], v[166:167]
    v_pk_add_f32 v[164:165], v[164:165], v[166:167]
    v_add_f32 v164, v164, v165
    s_nop 1
    v_add_f32_dpp v164, v164, v164 row_ror:8 row_mask:0xf bank_mask:0xf
    s_nop 1
    v_add_f32_dpp v164, v164, v164 row_ror:4 row_mask:0xf bank_mask:0xf
    s_nop 1
    v_add_f32_dpp v164, v164, v164 row_ror:2 row_mask:0xf bank_mask:0xf
    s_nop 1
    v_add_f32_dpp v164, v164, v164 row_ror:1 row_mask:0xf bank_mask:0xf
    s_mov_b32 s50, 0x3727c5ac
    v_mov_b32 v165, s50
    v_fmac_f32 v165, 0x3b000000, v164
    v_mul_f32 v164, 0x3b000000, v164
    v_rsq_f32 v161, v165
    s_nop 0
    v_mul_f32 v167, v161, v161
    v_mov_b32 v168, s50
    v_fmac_f32 v168, v167, v164
    v_rsq_f32 v168, v168
    s_nop 0
    v_mul_f32 v166, v161, v168
    s_nop 0
    v_pk_mul_f32 v[128:129], v[128:129], v[166:167] op_sel_hi:[1,0]
    v_pk_mul_f32 v[130:131], v[130:131], v[166:167] op_sel_hi:[1,0]
    v_pk_mul_f32 v[132:133], v[132:133], v[166:167] op_sel_hi:[1,0]
    v_pk_mul_f32 v[134:135], v[134:135], v[166:167] op_sel_hi:[1,0]
    v_pk_mul_f32 v[136:137], v[136:137], v[166:167] op_sel_hi:[1,0]
    v_pk_mul_f32 v[138:139], v[138:139], v[166:167] op_sel_hi:[1,0]
    v_pk_mul_f32 v[140:141], v[140:141], v[166:167] op_sel_hi:[1,0]
    v_pk_mul_f32 v[142:143], v[142:143], v[166:167] op_sel_hi:[1,0]
    v_pk_mul_f32 v[144:145], v[144:145], v[166:167] op_sel_hi:[1,0]
    v_pk_mul_f32 v[146:147], v[146:147], v[166:167] op_sel_hi:[1,0]
    v_pk_mul_f32 v[148:149], v[148:149], v[166:167] op_sel_hi:[1,0]
    v_pk_mul_f32 v[150:151], v[150:151], v[166:167] op_sel_hi:[1,0]
    v_pk_mul_f32 v[152:153], v[152:153], v[166:167] op_sel_hi:[1,0]
    v_pk_mul_f32 v[154:155], v[154:155], v[166:167] op_sel_hi:[1,0]
    v_pk_mul_f32 v[156:157], v[156:157], v[166:167] op_sel_hi:[1,0]
    v_pk_mul_f32 v[158:159], v[158:159], v[166:167] op_sel_hi:[1,0]
    v_cvt_pk_bf16_f32 v200, v128, v129
    v_cvt_pk_bf16_f32 v201, v130, v131
    v_cvt_pk_bf16_f32 v202, v132, v133
    v_cvt_pk_bf16_f32 v203, v134, v135
    v_cvt_pk_bf16_f32 v204, v136, v137
    v_cvt_pk_bf16_f32 v205, v138, v139
    v_cvt_pk_bf16_f32 v206, v140, v141
    v_cvt_pk_bf16_f32 v207, v142, v143
    v_cvt_pk_bf16_f32 v208, v144, v145
    v_cvt_pk_bf16_f32 v209, v146, v147
    v_cvt_pk_bf16_f32 v210, v148, v149
    v_cvt_pk_bf16_f32 v211, v150, v151
    v_cvt_pk_bf16_f32 v212, v152, v153
    v_cvt_pk_bf16_f32 v213, v154, v155
    v_cvt_pk_bf16_f32 v214, v156, v157
    v_cvt_pk_bf16_f32 v215, v158, v159
    ds_write_b128 v5, v[200:203] offset:0
    ds_write_b128 v5, v[204:207] offset:256
    ds_write_b128 v5, v[208:211] offset:512
    ds_write_b128 v5, v[212:215] offset:768
    s_lshl_b32 s51, s73, 6
    s_add_u32 s51, s51, 0x600000
    v_lshlrev_b32 v7, 2, v2
    v_cmp_eq_u32 vcc, 0, v3
    s_and_saveexec_b64 s[52:53], vcc
    buffer_store_dword v160, v7, s[28:31], s51 offen sc1
    s_add_u32 s51, s51, 8192
    buffer_store_dword v161, v7, s[28:31], s51 offen sc1
    s_mov_b64 exec, s[52:53]
    s_waitcnt lgkmcnt(0)
    s_barrier
    ds_read_b64_tr_b16 v[128:129], v6 offset:0
    ds_read_b64_tr_b16 v[130:131], v6 offset:4352
    ds_read_b64_tr_b16 v[132:133], v6 offset:64
    ds_read_b64_tr_b16 v[134:135], v6 offset:4416
    ds_read_b64_tr_b16 v[136:137], v6 offset:128
    ds_read_b64_tr_b16 v[138:139], v6 offset:4480
    ds_read_b64_tr_b16 v[140:141], v6 offset:192
    ds_read_b64_tr_b16 v[142:143], v6 offset:4544
    s_lshl_b32 s51, s26, 19
    s_lshl_b32 s52, s73, 10
    s_add_u32 s51, s51, s52
    s_waitcnt lgkmcnt(6)
    buffer_store_dwordx4 v[128:131], v11, s[28:31], s51 offen sc1
    s_add_u32 s51, s51, 0x20000
    s_waitcnt lgkmcnt(4)
    buffer_store_dwordx4 v[132:135], v11, s[28:31], s51 offen sc1
    s_add_u32 s51, s51, 0x20000
    s_waitcnt lgkmcnt(2)
    buffer_store_dwordx4 v[136:139], v11, s[28:31], s51 offen sc1
    s_add_u32 s51, s51, 0x20000
    s_waitcnt lgkmcnt(0)
    buffer_store_dwordx4 v[140:143], v11, s[28:31], s51 offen sc1
    v_mov_b32 v2, 0
    buffer_load_dwordx2 v[36:37], v2, s[44:47], 0 offen sc1
    s_add_u32 m0, s58, 8192
    s_add_u32 s48, s61, 44032
    buffer_load_dwordx4 v10, s[32:35], s61 offen lds
    s_add_u32 m0, s58, 9216
    s_cmp_eq_u32 s48, s55
    buffer_load_dwordx4 v9, s[32:35], s61 offen lds
    s_cselect_b32 s61, s60, s48
    s_add_u32 m0, s58, 10240
    s_add_u32 s48, s61, 44032
    buffer_load_dwordx4 v10, s[32:35], s61 offen lds
    s_add_u32 m0, s58, 11264
    s_cmp_eq_u32 s48, s55
    buffer_load_dwordx4 v9, s[32:35], s61 offen lds
    s_cselect_b32 s61, s60, s48
    s_add_u32 m0, s58, 12288
    s_add_u32 s48, s61, 44032
    buffer_load_dwordx4 v10, s[32:35], s61 offen lds
    s_add_u32 m0, s58, 13312
    s_cmp_eq_u32 s48, s55
    buffer_load_dwordx4 v9, s[32:35], s61 offen lds
    s_cselect_b32 s61, s60, s48
    s_add_u32 m0, s58, 14336
    s_add_u32 s48, s61, 44032
    buffer_load_dwordx4 v10, s[32:35], s61 offen lds
    s_add_u32 m0, s58, 15360
    s_cmp_eq_u32 s48, s55
    buffer_load_dwordx4 v9, s[32:35], s61 offen lds
    s_cselect_b32 s61, s60, s48
    s_waitcnt vmcnt(8)
    v_readfirstlane_b32 s74, v36
    v_readfirstlane_b32 s75, v37
    s_or_b32 s49, s74, s75
    s_cmp_lg_u32 s49, 0
    s_cbranch_scc1 Lnok_3
    s_mov_b32 s48, 0
Lnp_4:
    v_mov_b32 v2, 0
    buffer_load_dwordx2 v[4:5], v2, s[44:47], 0 offen sc1
    s_waitcnt vmcnt(0)
    v_readfirstlane_b32 s74, v4
    v_readfirstlane_b32 s75, v5
    s_add_u32 s48, s48, 1
    s_or_b32 s49, s74, s75
    s_cmp_lg_u32 s49, 0
    s_cbranch_scc1 Lnd_5
    s_cmp_lt_u32 s48, 200000
    s_cbranch_scc1 Lnp_4
Lnd_5:
Lnok_3:
    s_mul_i32 s72, s73, 64
    s_add_u32 s72, s72, 0x700000
    s_barrier
    s_cmp_lg_u32 s26, 0
    s_cbranch_scc1 Lf_6
    v_mov_b32 v4, s74
    v_mov_b32 v5, s75
    v_mov_b32 v2, 0
    s_mov_b64 exec, 1
    buffer_store_dwordx2 v[4:5], v2, s[28:31], s72 offen sc1
    s_mov_b64 exec, -1
Lf_6:
    s_add_u32 m0, s58, 16384
    s_add_u32 s48, s61, 44032
    buffer_load_dwordx4 v10, s[32:35], s61 offen lds
    s_add_u32 m0, s58, 17408
    s_cmp_eq_u32 s48, s55
    buffer_load_dwordx4 v9, s[32:35], s61 offen lds
    s_cselect_b32 s61, s60, s48
    s_add_u32 m0, s58, 18432
    s_add_u32 s48, s61, 44032
    buffer_load_dwordx4 v10, s[32:35], s61 offen lds
    s_add_u32 m0, s58, 19456
    s_cmp_eq_u32 s48, s55
    buffer_load_dwordx4 v9, s[32:35], s61 offen lds
    s_cselect_b32 s61, s60, s48
    s_add_u32 m0, s58, 20480
    s_add_u32 s48, s61, 44032
    buffer_load_dwordx4 v10, s[32:35], s61 offen lds
    s_add_u32 m0, s58, 21504
    s_cmp_eq_u32 s48, s55
    buffer_load_dwordx4 v9, s[32:35], s61 offen lds
    s_cselect_b32 s61, s60, s48
    s_add_u32 m0, s58, 22528
    s_add_u32 s48, s61, 44032
    buffer_load_dwordx4 v10, s[32:35], s61 offen lds
    s_add_u32 m0, s58, 23552
    s_cmp_eq_u32 s48, s55
    buffer_load_dwordx4 v9, s[32:35], s61 offen lds
    s_cselect_b32 s61, s60, s48
    s_branch L_ujoin
L_noln:
    s_mov_b32 s32, s12
    s_and_b32 s33, s13, 0xffff
    s_mov_b32 s34, 0x560000
    s_mov_b32 s35, 0x20000
    s_lshr_b32 s56, s26, 1
    s_and_b32 s57, s26, 1
    s_mul_i32 s58, s26, 24576
    v_lshrrev_b32 v2, 3, v1
    v_and_b32 v3, 7, v1
    v_bfe_u32 v4, v1, 4, 1
    v_lshlrev_b32 v4, 2, v4
    v_xor_b32 v3, v3, v4
    s_mov_b32 s48, 2752
    v_mul_lo_u32 v2, v2, s48
    v_lshl_add_u32 v10, v3, 4, v2
    v_bfe_u32 v2, v1, 2, 2
    v_lshrrev_b32 v3, 5, v1
    v_bfe_u32 v4, v1, 4, 1
    v_and_b32 v5, 3, v1
    v_lshl_add_u32 v6, v3, 3, v2
    v_lshlrev_b32 v6, 7, v6
    v_lshrrev_b32 v7, 1, v2
    v_xor_b32 v7, s56, v7
    v_lshl_add_u32 v6, v7, 6, v6
    v_lshl_add_u32 v6, v4, 5, v6
    v_lshrrev_b32 v7, 1, v5
    v_lshl_add_u32 v6, v7, 4, v6
    v_and_b32 v7, 1, v5
    v_lshl_add_u32 v6, v7, 3, v6
    v_add_u32 v12, s58, v6
    v_xor_b32 v13, 64, v12
    s_lshl_b32 s60, s76, 7
    s_mul_i32 s48, s26, 1409024
    s_add_u32 s60, s60, s48
    s_add_u32 s61, s60, 22016
    s_lshl_b32 s62, s77, 1
    s_add_u32 s62, s62, s57
    s_xor_b32 s63, s62, 1
    s_lshl_b32 s62, s62, 17
    s_lshl_b32 s63, s63, 17
    s_lshl_b32 s48, s26, 15
    s_add_u32 s62, s62, s48
    s_add_u32 s63, s63, s48
    s_and_b32 s48, s76, 7
    s_mul_i32 s48, s48, 5
    s_and_b32 s65, s77, 3
    s_lshl_b32 s65, s65, 3
    s_add_u32 s65, s65, s48
    s_lshr_b32 s48, s77, 2
    s_lshl_b32 s48, s48, 2
    s_add_u32 s65, s65, s48
    s_and_b32 s59, s65, 31
    s_mul_i32 s61, s59, 44032
    s_add_u32 s61, s61, s60
    s_add_u32 s55, s60, 1409024
    v_add_u32 v9, 22016, v10
    s_lshl_b32 s59, s59, 10
    v_add_u32 v16, s62, v11
    v_add_u32 v17, s63, v11
    s_mov_b32 s36, s14
    s_and_b32 s37, s15, 0xffff
    s_mov_b32 s38, 0xac0
    s_mov_b32 s39, 0x20000
    v_lshrrev_b32 v2, 5, v1
    v_lshlrev_b32 v2, 3, v2
    s_lshl_b32 s64, s76, 7
    s_lshl_b32 s48, s56, 6
    s_add_u32 s64, s64, s48
    buffer_load_dwordx2 v[40:41], v2, s[36:39], s64 offen offset:0
    buffer_load_dwordx2 v[42:43], v2, s[36:39], s64 offen offset:16
    buffer_load_dwordx2 v[44:45], v2, s[36:39], s64 offen offset:32
    buffer_load_dwordx2 v[46:47], v2, s[36:39], s64 offen offset:48
    s_add_u32 m0, s58, 0
    s_add_u32 s48, s61, 44032
    buffer_load_dwordx4 v10, s[32:35], s61 offen lds
    s_add_u32 m0, s58, 1024
    s_cmp_eq_u32 s48, s55
    buffer_load_dwordx4 v9, s[32:35], s61 offen lds
    s_cselect_b32 s61, s60, s48
    s_add_u32 m0, s58, 2048
    s_add_u32 s48, s61, 44032
    buffer_load_dwordx4 v10, s[32:35], s61 offen lds
    s_add_u32 m0, s58, 3072
    s_cmp_eq_u32 s48, s55
    buffer_load_dwordx4 v9, s[32:35], s61 offen lds
    s_cselect_b32 s61, s60, s48
    s_add_u32 m0, s58, 4096
    s_add_u32 s48, s61, 44032
    buffer_load_dwordx4 v10, s[32:35], s61 offen lds
    s_add_u32 m0, s58, 5120
    s_cmp_eq_u32 s48, s55
    buffer_load_dwordx4 v9, s[32:35], s61 offen lds
    s_cselect_b32 s61, s60, s48
    s_add_u32 m0, s58, 6144
    s_add_u32 s48, s61, 44032
    buffer_load_dwordx4 v10, s[32:35], s61 offen lds
    s_add_u32 m0, s58, 7168
    s_cmp_eq_u32 s48, s55
    buffer_load_dwordx4 v9, s[32:35], s61 offen lds
    s_cselect_b32 s61, s60, s48
    s_add_u32 m0, s58, 8192
    s_add_u32 s48, s61, 44032
    buffer_load_dwordx4 v10, s[32:35], s61 offen lds
    s_add_u32 m0, s58, 9216
    s_cmp_eq_u32 s48, s55
    buffer_load_dwordx4 v9, s[32:35], s61 offen lds
    s_cselect_b32 s61, s60, s48
    s_add_u32 m0, s58, 10240
    s_add_u32 s48, s61, 44032
    buffer_load_dwordx4 v10, s[32:35], s61 offen lds
    s_add_u32 m0, s58, 11264
    s_cmp_eq_u32 s48, s55
    buffer_load_dwordx4 v9, s[32:35], s61 offen lds
    s_cselect_b32 s61, s60, s48
    s_add_u32 m0, s58, 12288
    s_add_u32 s48, s61, 44032
    buffer_load_dwordx4 v10, s[32:35], s61 offen lds
    s_add_u32 m0, s58, 13312
    s_cmp_eq_u32 s48, s55
    buffer_load_dwordx4 v9, s[32:35], s61 offen lds
    s_cselect_b32 s61, s60, s48
    s_add_u32 m0, s58, 14336
    s_add_u32 s48, s61, 44032
    buffer_load_dwordx4 v10, s[32:35], s61 offen lds
    s_add_u32 m0, s58, 15360
    s_cmp_eq_u32 s48, s55
    buffer_load_dwordx4 v9, s[32:35], s61 offen lds
    s_cselect_b32 s61, s60, s48
    s_add_u32 m0, s58, 16384
    s_add_u32 s48, s61, 44032
    buffer_load_dwordx4 v10, s[32:35], s61 offen lds
    s_add_u32 m0, s58, 17408
    s_cmp_eq_u32 s48, s55
    buffer_load_dwordx4 v9, s[32:35], s61 offen lds
    s_cselect_b32 s61, s60, s48
    s_add_u32 m0, s58, 18432
    s_add_u32 s48, s61, 44032
    buffer_load_dwordx4 v10, s[32:35], s61 offen lds
    s_add_u32 m0, s58, 19456
    s_cmp_eq_u32 s48, s55
    buffer_load_dwordx4 v9, s[32:35], s61 offen lds
    s_cselect_b32 s61, s60, s48
    s_add_u32 m0, s58, 20480
    s_add_u32 s48, s61, 44032
    buffer_load_dwordx4 v10, s[32:35], s61 offen lds
    s_add_u32 m0, s58, 21504
    s_cmp_eq_u32 s48, s55
    buffer_load_dwordx4 v9, s[32:35], s61 offen lds
    s_cselect_b32 s61, s60, s48
    s_add_u32 m0, s58, 22528
    s_add_u32 s48, s61, 44032
    buffer_load_dwordx4 v10, s[32:35], s61 offen lds
    s_add_u32 m0, s58, 23552
    s_cmp_eq_u32 s48, s55
    buffer_load_dwordx4 v9, s[32:35], s61 offen lds
    s_cselect_b32 s61, s60, s48
    s_mov_b32 s74, 0
    s_mov_b32 s75, 0
L_ujoin:
    v_and_b32 v2, 31, v1
    s_lshl_b32 s48, s26, 5
    v_add_u32 v2, s48, v2
    v_mul_u32_u24 v2, 64, v2
    v_add_u32 v20, 0x700000, v2
    s_waitcnt vmcnt(16)
    ds_read_b64_tr_b16 a[0:1], v12 offset:0
    ds_read_b64_tr_b16 a[2:3], v12 offset:512
    ds_read_b64_tr_b16 a[4:5], v13 offset:0
    ds_read_b64_tr_b16 a[6:7], v13 offset:512
    ds_read_b64_tr_b16 a[8:9], v12 offset:2048
    ds_read_b64_tr_b16 a[10:11], v12 offset:2560
    ds_read_b64_tr_b16 a[12:13], v13 offset:2048
    ds_read_b64_tr_b16 a[14:15], v13 offset:2560
    s_waitcnt lgkmcnt(4)
    ds_read_b64_tr_b16 a[16:17], v12 offset:4096
    ds_read_b64_tr_b16 a[18:19], v12 offset:4608
    ds_read_b64_tr_b16 a[20:21], v13 offset:4096
    ds_read_b64_tr_b16 a[22:23], v13 offset:4608
    ds_read_b64_tr_b16 a[24:25], v12 offset:6144
    ds_read_b64_tr_b16 a[26:27], v12 offset:6656
    ds_read_b64_tr_b16 a[28:29], v13 offset:6144
    ds_read_b64_tr_b16 a[30:31], v13 offset:6656
    s_waitcnt lgkmcnt(4)
    s_waitcnt lgkmcnt(0)
    s_add_u32 m0, s58, 0
    s_add_u32 s48, s61, 44032
    buffer_load_dwordx4 v10, s[32:35], s61 offen lds
    s_add_u32 m0, s58, 1024
    s_cmp_eq_u32 s48, s55
    buffer_load_dwordx4 v9, s[32:35], s61 offen lds
    s_cselect_b32 s61, s60, s48
    s_add_u32 m0, s58, 2048
    s_add_u32 s48, s61, 44032
    buffer_load_dwordx4 v10, s[32:35], s61 offen lds
    s_add_u32 m0, s58, 3072
    s_cmp_eq_u32 s48, s55
    buffer_load_dwordx4 v9, s[32:35], s61 offen lds
    s_cselect_b32 s61, s60, s48
    s_add_u32 m0, s58, 4096
    s_add_u32 s48, s61, 44032
    buffer_load_dwordx4 v10, s[32:35], s61 offen lds
    s_add_u32 m0, s58, 5120
    s_cmp_eq_u32 s48, s55
    buffer_load_dwordx4 v9, s[32:35], s61 offen lds
    s_cselect_b32 s61, s60, s48
    s_add_u32 m0, s58, 6144
    s_add_u32 s48, s61, 44032
    buffer_load_dwordx4 v10, s[32:35], s61 offen lds
    s_add_u32 m0, s58, 7168
    s_cmp_eq_u32 s48, s55
    buffer_load_dwordx4 v9, s[32:35], s61 offen lds
    s_cselect_b32 s61, s60, s48
    s_waitcnt vmcnt(16)
    ds_read_b64_tr_b16 a[32:33], v12 offset:8192
    ds_read_b64_tr_b16 a[34:35], v12 offset:8704
    ds_read_b64_tr_b16 a[36:37], v13 offset:8192
    ds_read_b64_tr_b16 a[38:39], v13 offset:8704
    ds_read_b64_tr_b16 a[40:41], v12 offset:10240
    ds_read_b64_tr_b16 a[42:43], v12 offset:10752
    ds_read_b64_tr_b16 a[44:45], v13 offset:10240
    ds_read_b64_tr_b16 a[46:47], v13 offset:10752
    s_waitcnt lgkmcnt(4)
    ds_read_b64_tr_b16 a[48:49], v12 offset:12288
    ds_read_b64_tr_b16 a[50:51], v12 offset:12800
    ds_read_b64_tr_b16 a[52:53], v13 offset:12288
    ds_read_b64_tr_b16 a[54:55], v13 offset:12800
    ds_read_b64_tr_b16 a[56:57], v12 offset:14336
    ds_read_b64_tr_b16 a[58:59], v12 offset:14848
    ds_read_b64_tr_b16 a[60:61], v13 offset:14336
    ds_read_b64_tr_b16 a[62:63], v13 offset:14848
    s_waitcnt lgkmcnt(4)
    s_waitcnt lgkmcnt(0)
    s_add_u32 m0, s58, 8192
    s_add_u32 s48, s61, 44032
    buffer_load_dwordx4 v10, s[32:35], s61 offen lds
    s_add_u32 m0, s58, 9216
    s_cmp_eq_u32 s48, s55
    buffer_load_dwordx4 v9, s[32:35], s61 offen lds
    s_cselect_b32 s61, s60, s48
    s_add_u32 m0, s58, 10240
    s_add_u32 s48, s61, 44032
    buffer_load_dwordx4 v10, s[32:35], s61 offen lds
    s_add_u32 m0, s58, 11264
    s_cmp_eq_u32 s48, s55
    buffer_load_dwordx4 v9, s[32:35], s61 offen lds
    s_cselect_b32 s61, s60, s48
    s_add_u32 m0, s58, 12288
    s_add_u32 s48, s61, 44032
    buffer_load_dwordx4 v10, s[32:35], s61 offen lds
    s_add_u32 m0, s58, 13312
    s_cmp_eq_u32 s48, s55
    buffer_load_dwordx4 v9, s[32:35], s61 offen lds
    s_cselect_b32 s61, s60, s48
    s_add_u32 m0, s58, 14336
    s_add_u32 s48, s61, 44032
    buffer_load_dwordx4 v10, s[32:35], s61 offen lds
    s_add_u32 m0, s58, 15360
    s_cmp_eq_u32 s48, s55
    buffer_load_dwordx4 v9, s[32:35], s61 offen lds
    s_cselect_b32 s61, s60, s48
    v_mov_b32 v2, 0
    buffer_load_dwordx2 v[36:37], v2, s[44:47], 0 offen sc1
    s_waitcnt vmcnt(21)
    ds_read_b64_tr_b16 a[64:65], v12 offset:16384
    ds_read_b64_tr_b16 a[66:67], v12 offset:16896
    ds_read_b64_tr_b16 a[68:69], v13 offset:16384
    ds_read_b64_tr_b16 a[70:71], v13 offset:16896
    ds_read_b64_tr_b16 a[72:73], v12 offset:18432
    ds_read_b64_tr_b16 a[74:75], v12 offset:18944
    ds_read_b64_tr_b16 a[76:77], v13 offset:18432
    ds_read_b64_tr_b16 a[78:79], v13 offset:18944
    s_waitcnt lgkmcnt(4)
    s_waitcnt lgkmcnt(0)
    s_add_u32 m0, s58, 16384
    s_add_u32 s48, s61, 44032
    buffer_load_dwordx4 v10, s[32:35], s61 offen lds
    s_add_u32 m0, s58, 17408
    s_cmp_eq_u32 s48, s55
    buffer_load_dwordx4 v9, s[32:35], s61 offen lds
    s_cselect_b32 s61, s60, s48
    s_add_u32 m0, s58, 18432
    s_add_u32 s48, s61, 44032
    buffer_load_dwordx4 v10, s[32:35], s61 offen lds
    s_add_u32 m0, s58, 19456
    s_cmp_eq_u32 s48, s55
    buffer_load_dwordx4 v9, s[32:35], s61 offen lds
    s_cselect_b32 s61, s60, s48
    buffer_load_dwordx2 v[30:31], v20, s[28:31], 0 offen sc1
    s_waitcnt vmcnt(22)
    ds_read_b64_tr_b16 a[80:81], v12 offset:20480
    ds_read_b64_tr_b16 a[82:83], v12 offset:20992
    ds_read_b64_tr_b16 a[84:85], v13 offset:20480
    ds_read_b64_tr_b16 a[86:87], v13 offset:20992
    ds_read_b64_tr_b16 a[88:89], v12 offset:22528
    ds_read_b64_tr_b16 a[90:91], v12 offset:23040
    ds_read_b64_tr_b16 a[92:93], v13 offset:22528
    ds_read_b64_tr_b16 a[94:95], v13 offset:23040
    s_waitcnt lgkmcnt(4)
    s_waitcnt lgkmcnt(0)
    s_add_u32 m0, s58, 20480
    s_add_u32 s48, s61, 44032
    buffer_load_dwordx4 v10, s[32:35], s61 offen lds
    s_add_u32 m0, s58, 21504
    s_cmp_eq_u32 s48, s55
    buffer_load_dwordx4 v9, s[32:35], s61 offen lds
    s_cselect_b32 s61, s60, s48
    s_add_u32 m0, s58, 22528
    s_add_u32 s48, s61, 44032
    buffer_load_dwordx4 v10, s[32:35], s61 offen lds
    s_add_u32 m0, s58, 23552
    s_cmp_eq_u32 s48, s55
    buffer_load_dwordx4 v9, s[32:35], s61 offen lds
    s_cselect_b32 s61, s60, s48
    s_waitcnt vmcnt(9)
    v_readfirstlane_b32 s74, v36
    v_readfirstlane_b32 s75, v37
    s_or_b32 s49, s74, s75
    s_cmp_lg_u32 s49, 0
    s_cbranch_scc1 Lnok_7
    s_mov_b32 s48, 0
Lnp_8:
    v_mov_b32 v2, 0
    buffer_load_dwordx2 v[4:5], v2, s[44:47], 0 offen sc1
    s_waitcnt vmcnt(0)
    v_readfirstlane_b32 s74, v4
    v_readfirstlane_b32 s75, v5
    s_add_u32 s48, s48, 1
    s_or_b32 s49, s74, s75
    s_cmp_lg_u32 s49, 0
    s_cbranch_scc1 Lnd_9
    s_cmp_lt_u32 s48, 200000
    s_cbranch_scc1 Lnp_8
Lnd_9:
Lnok_7:
    s_nop 1
    s_waitcnt vmcnt(4)
    v_cmp_ne_u32 vcc, s74, v30
    v_cmp_ne_u32 s[50:51], s75, v31
    s_or_b64 vcc, vcc, s[50:51]
    s_cbranch_vccz Lok_10
    s_mov_b32 s48, 0
Lp_11:
    buffer_load_dwordx2 v[4:5], v20, s[28:31], 0 offen sc1
    s_add_u32 s48, s48, 1
    s_waitcnt vmcnt(0)
    v_cmp_ne_u32 vcc, s74, v4
    v_cmp_ne_u32 s[50:51], s75, v5
    s_or_b64 vcc, vcc, s[50:51]
    s_cbranch_vccz Ld_12
    s_cmp_lt_u32 s48, 200000
    s_cbranch_scc0 Ld_12
    s_sleep 1
    s_branch Lp_11
Ld_12:
Lok_10:
    buffer_load_dwordx4 v[128:131], v16, s[28:31], s59 offen
    buffer_load_dwordx4 v[132:135], v17, s[28:31], s59 offen
    s_add_u32 s59, s59, 1024
    s_and_b32 s59, s59, 0x7fff
    buffer_load_dwordx4 v[136:139], v16, s[28:31], s59 offen
    buffer_load_dwordx4 v[140:143], v17, s[28:31], s59 offen
    s_add_u32 s59, s59, 1024
    s_and_b32 s59, s59, 0x7fff
    buffer_load_dwordx4 v[144:147], v16, s[28:31], s59 offen
    buffer_load_dwordx4 v[148:151], v17, s[28:31], s59 offen
    s_add_u32 s59, s59, 1024
    s_and_b32 s59, s59, 0x7fff
    buffer_load_dwordx4 v[152:155], v16, s[28:31], s59 offen
    buffer_load_dwordx4 v[156:159], v17, s[28:31], s59 offen
    s_add_u32 s59, s59, 1024
    s_and_b32 s59, s59, 0x7fff
    buffer_load_dwordx4 v[160:163], v16, s[28:31], s59 offen
    buffer_load_dwordx4 v[164:167], v17, s[28:31], s59 offen
    s_add_u32 s59, s59, 1024
    s_and_b32 s59, s59, 0x7fff
    buffer_load_dwordx4 v[168:171], v16, s[28:31], s59 offen
    buffer_load_dwordx4 v[172:175], v17, s[28:31], s59 offen
    s_add_u32 s59, s59, 1024
    s_and_b32 s59, s59, 0x7fff
    buffer_load_dwordx4 v[176:179], v16, s[28:31], s59 offen
    buffer_load_dwordx4 v[180:183], v17, s[28:31], s59 offen
    s_add_u32 s59, s59, 1024
    s_and_b32 s59, s59, 0x7fff
    buffer_load_dwordx4 v[184:187], v16, s[28:31], s59 offen
    buffer_load_dwordx4 v[188:191], v17, s[28:31], s59 offen
    s_add_u32 s59, s59, 1024
    s_and_b32 s59, s59, 0x7fff
    ds_read_b64_tr_b16 a[96:97], v12 offset:0
    ds_read_b64_tr_b16 a[98:99], v12 offset:512
    ds_read_b64_tr_b16 a[100:101], v13 offset:0
    ds_read_b64_tr_b16 a[102:103], v13 offset:512
    s_waitcnt vmcnt(14)
    v_mfma_f32_32x32x16_bf16 v[64:79], a[0:3], v[128:131], 0
    v_mfma_f32_32x32x16_bf16 v[96:111], a[4:7], v[128:131], 0
    buffer_load_dwordx4 v[128:131], v16, s[28:31], s59 offen
    v_mfma_f32_32x32x16_bf16 v[80:95], a[0:3], v[132:135], 0
    v_mfma_f32_32x32x16_bf16 v[112:127], a[4:7], v[132:135], 0
    buffer_load_dwordx4 v[132:135], v17, s[28:31], s59 offen
    s_add_u32 s59, s59, 1024
    s_and_b32 s59, s59, 0x7fff
    s_waitcnt lgkmcnt(0)
    s_add_u32 m0, s58, 0
    s_add_u32 s48, s61, 44032
    buffer_load_dwordx4 v10, s[32:35], s61 offen lds
    s_add_u32 m0, s58, 1024
    s_cmp_eq_u32 s48, s55
    buffer_load_dwordx4 v9, s[32:35], s61 offen lds
    s_cselect_b32 s61, s60, s48
    ds_read_b64_tr_b16 a[104:105], v12 offset:2048
    ds_read_b64_tr_b16 a[106:107], v12 offset:2560
    ds_read_b64_tr_b16 a[108:109], v13 offset:2048
    ds_read_b64_tr_b16 a[110:111], v13 offset:2560
    s_waitcnt vmcnt(16)
    v_mfma_f32_32x32x16_bf16 v[64:79], a[8:11], v[136:139], v[64:79]
    v_mfma_f32_32x32x16_bf16 v[96:111], a[12:15], v[136:139], v[96:111]
    buffer_load_dwordx4 v[136:139], v16, s[28:31], s59 offen
    v_mfma_f32_32x32x16_bf16 v[80:95], a[8:11], v[140:143], v[80:95]
    v_mfma_f32_32x32x16_bf16 v[112:127], a[12:15], v[140:143], v[112:127]
    buffer_load_dwordx4 v[140:143], v17, s[28:31], s59 offen
    s_add_u32 s59, s59, 1024
    s_and_b32 s59, s59, 0x7fff
    s_waitcnt lgkmcnt(0)
    s_add_u32 m0, s58, 2048
    s_add_u32 s48, s61, 44032
    buffer_load_dwordx4 v10, s[32:35], s61 offen lds
    s_add_u32 m0, s58, 3072
    s_cmp_eq_u32 s48, s55
    buffer_load_dwordx4 v9, s[32:35], s61 offen lds
    s_cselect_b32 s61, s60, s48
    ds_read_b64_tr_b16 a[112:113], v12 offset:4096
    ds_read_b64_tr_b16 a[114:115], v12 offset:4608
    ds_read_b64_tr_b16 a[116:117], v13 offset:4096
    ds_read_b64_tr_b16 a[118:119], v13 offset:4608
    s_waitcnt vmcnt(18)
    v_mfma_f32_32x32x16_bf16 v[64:79], a[16:19], v[144:147], v[64:79]
    v_mfma_f32_32x32x16_bf16 v[96:111], a[20:23], v[144:147], v[96:111]
    buffer_load_dwordx4 v[144:147], v16, s[28:31], s59 offen
    v_mfma_f32_32x32x16_bf16 v[80:95], a[16:19], v[148:151], v[80:95]
    v_mfma_f32_32x32x16_bf16 v[112:127], a[20:23], v[148:151], v[112:127]
    buffer_load_dwordx4 v[148:151], v17, s[28:31], s59 offen
    s_add_u32 s59, s59, 1024
    s_and_b32 s59, s59, 0x7fff
    s_waitcnt lgkmcnt(0)
    s_add_u32 m0, s58, 4096
    s_add_u32 s48, s61, 44032
    buffer_load_dwordx4 v10, s[32:35], s61 offen lds
    s_add_u32 m0, s58, 5120
    s_cmp_eq_u32 s48, s55
    buffer_load_dwordx4 v9, s[32:35], s61 offen lds
    s_cselect_b32 s61, s60, s48
    ds_read_b64_tr_b16 a[120:121], v12 offset:6144
    ds_read_b64_tr_b16 a[122:123], v12 offset:6656
    ds_read_b64_tr_b16 a[124:125], v13 offset:6144
    ds_read_b64_tr_b16 a[126:127], v13 offset:6656
    s_waitcnt vmcnt(20)
    v_mfma_f32_32x32x16_bf16 v[64:79], a[24:27], v[152:155], v[64:79]
    v_mfma_f32_32x32x16_bf16 v[96:111], a[28:31], v[152:155], v[96:111]
    buffer_load_dwordx4 v[152:155], v16, s[28:31], s59 offen
    v_mfma_f32_32x32x16_bf16 v[80:95], a[24:27], v[156:159], v[80:95]
    v_mfma_f32_32x32x16_bf16 v[112:127], a[28:31], v[156:159], v[112:127]
    buffer_load_dwordx4 v[156:159], v17, s[28:31], s59 offen
    s_add_u32 s59, s59, 1024
    s_and_b32 s59, s59, 0x7fff
    s_waitcnt lgkmcnt(0)
    s_add_u32 m0, s58, 6144
    s_add_u32 s48, s61, 44032
    buffer_load_dwordx4 v10, s[32:35], s61 offen lds
    s_add_u32 m0, s58, 7168
    s_cmp_eq_u32 s48, s55
    buffer_load_dwordx4 v9, s[32:35], s61 offen lds
    s_cselect_b32 s61, s60, s48
    ds_read_b64_tr_b16 a[128:129], v12 offset:8192
    ds_read_b64_tr_b16 a[130:131], v12 offset:8704
    ds_read_b64_tr_b16 a[132:133], v13 offset:8192
    ds_read_b64_tr_b16 a[134:135], v13 offset:8704
    s_waitcnt vmcnt(22)
    v_mfma_f32_32x32x16_bf16 v[64:79], a[32:35], v[160:163], v[64:79]
    v_mfma_f32_32x32x16_bf16 v[96:111], a[36:39], v[160:163], v[96:111]
    buffer_load_dwordx4 v[160:163], v16, s[28:31], s59 offen
    v_mfma_f32_32x32x16_bf16 v[80:95], a[32:35], v[164:167], v[80:95]
    v_mfma_f32_32x32x16_bf16 v[112:127], a[36:39], v[164:167], v[112:127]
    buffer_load_dwordx4 v[164:167], v17, s[28:31], s59 offen
    s_add_u32 s59, s59, 1024
    s_and_b32 s59, s59, 0x7fff
    s_waitcnt lgkmcnt(0)
    s_add_u32 m0, s58, 8192
    s_add_u32 s48, s61, 44032
    buffer_load_dwordx4 v10, s[32:35], s61 offen lds
    s_add_u32 m0, s58, 9216
    s_cmp_eq_u32 s48, s55
    buffer_load_dwordx4 v9, s[32:35], s61 offen lds
    s_cselect_b32 s61, s60, s48
    ds_read_b64_tr_b16 a[136:137], v12 offset:10240
    ds_read_b64_tr_b16 a[138:139], v12 offset:10752
    ds_read_b64_tr_b16 a[140:141], v13 offset:10240
    ds_read_b64_tr_b16 a[142:143], v13 offset:10752
    s_waitcnt vmcnt(24)
    v_mfma_f32_32x32x16_bf16 v[64:79], a[40:43], v[168:171], v[64:79]
    v_mfma_f32_32x32x16_bf16 v[96:111], a[44:47], v[168:171], v[96:111]
    buffer_load_dwordx4 v[168:171], v16, s[28:31], s59 offen
    v_mfma_f32_32x32x16_bf16 v[80:95], a[40:43], v[172:175], v[80:95]
    v_mfma_f32_32x32x16_bf16 v[112:127], a[44:47], v[172:175], v[112:127]
    buffer_load_dwordx4 v[172:175], v17, s[28:31], s59 offen
    s_add_u32 s59, s59, 1024
    s_and_b32 s59, s59, 0x7fff
    s_waitcnt lgkmcnt(0)
    s_add_u32 m0, s58, 10240
    s_add_u32 s48, s61, 44032
    buffer_load_dwordx4 v10, s[32:35], s61 offen lds
    s_add_u32 m0, s58, 11264
    s_cmp_eq_u32 s48, s55
    buffer_load_dwordx4 v9, s[32:35], s61 offen lds
    s_cselect_b32 s61, s60, s48
    ds_read_b64_tr_b16 a[144:145], v12 offset:12288
    ds_read_b64_tr_b16 a[146:147], v12 offset:12800
    ds_read_b64_tr_b16 a[148:149], v13 offset:12288
    ds_read_b64_tr_b16 a[150:151], v13 offset:12800
    s_waitcnt vmcnt(26)
    v_mfma_f32_32x32x16_bf16 v[64:79], a[48:51], v[176:179], v[64:79]
    v_mfma_f32_32x32x16_bf16 v[96:111], a[52:55], v[176:179], v[96:111]
    buffer_load_dwordx4 v[176:179], v16, s[28:31], s59 offen
    v_mfma_f32_32x32x16_bf16 v[80:95], a[48:51], v[180:183], v[80:95]
    v_mfma_f32_32x32x16_bf16 v[112:127], a[52:55], v[180:183], v[112:127]
    buffer_load_dwordx4 v[180:183], v17, s[28:31], s59 offen
    s_add_u32 s59, s59, 1024
    s_and_b32 s59, s59, 0x7fff
    s_waitcnt lgkmcnt(0)
    s_add_u32 m0, s58, 12288
    s_add_u32 s48, s61, 44032
    buffer_load_dwordx4 v10, s[32:35], s61 offen lds
    s_add_u32 m0, s58, 13312
    s_cmp_eq_u32 s48, s55
    buffer_load_dwordx4 v9, s[32:35], s61 offen lds
    s_cselect_b32 s61, s60, s48
    ds_read_b64_tr_b16 a[152:153], v12 offset:14336
    ds_read_b64_tr_b16 a[154:155], v12 offset:14848
    ds_read_b64_tr_b16 a[156:157], v13 offset:14336
    ds_read_b64_tr_b16 a[158:159], v13 offset:14848
    s_waitcnt vmcnt(28)
    v_mfma_f32_32x32x16_bf16 v[64:79], a[56:59], v[184:187], v[64:79]
    v_mfma_f32_32x32x16_bf16 v[96:111], a[60:63], v[184:187], v[96:111]
    buffer_load_dwordx4 v[184:187], v16, s[28:31], s59 offen
    v_mfma_f32_32x32x16_bf16 v[80:95], a[56:59], v[188:191], v[80:95]
    v_mfma_f32_32x32x16_bf16 v[112:127], a[60:63], v[188:191], v[112:127]
    buffer_load_dwordx4 v[188:191], v17, s[28:31], s59 offen
    s_add_u32 s59, s59, 1024
    s_and_b32 s59, s59, 0x7fff
    s_waitcnt lgkmcnt(0)
    s_add_u32 m0, s58, 14336
    s_add_u32 s48, s61, 44032
    buffer_load_dwordx4 v10, s[32:35], s61 offen lds
    s_add_u32 m0, s58, 15360
    s_cmp_eq_u32 s48, s55
    buffer_load_dwordx4 v9, s[32:35], s61 offen lds
    s_cselect_b32 s61, s60, s48
    ds_read_b64_tr_b16 a[160:161], v12 offset:16384
    ds_read_b64_tr_b16 a[162:163], v12 offset:16896
    ds_read_b64_tr_b16 a[164:165], v13 offset:16384
    ds_read_b64_tr_b16 a[166:167], v13 offset:16896
    s_waitcnt vmcnt(30)
    v_mfma_f32_32x32x16_bf16 v[64:79], a[64:67], v[128:131], v[64:79]
    v_mfma_f32_32x32x16_bf16 v[96:111], a[68:71], v[128:131], v[96:111]
    buffer_load_dwordx4 v[128:131], v16, s[28:31], s59 offen
    v_mfma_f32_32x32x16_bf16 v[80:95], a[64:67], v[132:135], v[80:95]
    v_mfma_f32_32x32x16_bf16 v[112:127], a[68:71], v[132:135], v[112:127]
    buffer_load_dwordx4 v[132:135], v17, s[28:31], s59 offen
    s_add_u32 s59, s59, 1024
    s_and_b32 s59, s59, 0x7fff
    s_waitcnt lgkmcnt(0)
    ds_read_b64_tr_b16 a[168:169], v12 offset:18432
    ds_read_b64_tr_b16 a[170:171], v12 offset:18944
    ds_read_b64_tr_b16 a[172:173], v13 offset:18432
    ds_read_b64_tr_b16 a[174:175], v13 offset:18944
    s_waitcnt vmcnt(28)
    v_mfma_f32_32x32x16_bf16 v[64:79], a[72:75], v[136:139], v[64:79]
    v_mfma_f32_32x32x16_bf16 v[96:111], a[76:79], v[136:139], v[96:111]
    buffer_load_dwordx4 v[136:139], v16, s[28:31], s59 offen
    v_mfma_f32_32x32x16_bf16 v[80:95], a[72:75], v[140:143], v[80:95]
    v_mfma_f32_32x32x16_bf16 v[112:127], a[76:79], v[140:143], v[112:127]
    buffer_load_dwordx4 v[140:143], v17, s[28:31], s59 offen
    s_add_u32 s59, s59, 1024
    s_and_b32 s59, s59, 0x7fff
    s_waitcnt lgkmcnt(0)
    ds_read_b64_tr_b16 a[176:177], v12 offset:20480
    ds_read_b64_tr_b16 a[178:179], v12 offset:20992
    ds_read_b64_tr_b16 a[180:181], v13 offset:20480
    ds_read_b64_tr_b16 a[182:183], v13 offset:20992
    s_waitcnt vmcnt(26)
    v_mfma_f32_32x32x16_bf16 v[64:79], a[80:83], v[144:147], v[64:79]
    v_mfma_f32_32x32x16_bf16 v[96:111], a[84:87], v[144:147], v[96:111]
    buffer_load_dwordx4 v[144:147], v16, s[28:31], s59 offen
    v_mfma_f32_32x32x16_bf16 v[80:95], a[80:83], v[148:151], v[80:95]
    v_mfma_f32_32x32x16_bf16 v[112:127], a[84:87], v[148:151], v[112:127]
    buffer_load_dwordx4 v[148:151], v17, s[28:31], s59 offen
    s_add_u32 s59, s59, 1024
    s_and_b32 s59, s59, 0x7fff
    s_waitcnt lgkmcnt(0)
    ds_read_b64_tr_b16 a[184:185], v12 offset:22528
    ds_read_b64_tr_b16 a[186:187], v12 offset:23040
    ds_read_b64_tr_b16 a[188:189], v13 offset:22528
    ds_read_b64_tr_b16 a[190:191], v13 offset:23040
    s_waitcnt vmcnt(24)
    v_mfma_f32_32x32x16_bf16 v[64:79], a[88:91], v[152:155], v[64:79]
    v_mfma_f32_32x32x16_bf16 v[96:111], a[92:95], v[152:155], v[96:111]
    buffer_load_dwordx4 v[152:155], v16, s[28:31], s59 offen
    v_mfma_f32_32x32x16_bf16 v[80:95], a[88:91], v[156:159], v[80:95]
    v_mfma_f32_32x32x16_bf16 v[112:127], a[92:95], v[156:159], v[112:127]
    buffer_load_dwordx4 v[156:159], v17, s[28:31], s59 offen
    s_add_u32 s59, s59, 1024
    s_and_b32 s59, s59, 0x7fff
    s_waitcnt lgkmcnt(0)
    ds_read_b64_tr_b16 a[192:193], v12 offset:0
    ds_read_b64_tr_b16 a[194:195], v12 offset:512
    ds_read_b64_tr_b16 a[196:197], v13 offset:0
    ds_read_b64_tr_b16 a[198:199], v13 offset:512
    s_waitcnt vmcnt(22)
    v_mfma_f32_32x32x16_bf16 v[64:79], a[96:99], v[160:163], v[64:79]
    v_mfma_f32_32x32x16_bf16 v[96:111], a[100:103], v[160:163], v[96:111]
    buffer_load_dwordx4 v[160:163], v16, s[28:31], s59 offen
    v_mfma_f32_32x32x16_bf16 v[80:95], a[96:99], v[164:167], v[80:95]
    v_mfma_f32_32x32x16_bf16 v[112:127], a[100:103], v[164:167], v[112:127]
    buffer_load_dwordx4 v[164:167], v17, s[28:31], s59 offen
    s_add_u32 s59, s59, 1024
    s_and_b32 s59, s59, 0x7fff
    s_waitcnt lgkmcnt(0)
    ds_read_b64_tr_b16 a[200:201], v12 offset:2048
    ds_read_b64_tr_b16 a[202:203], v12 offset:2560
    ds_read_b64_tr_b16 a[204:205], v13 offset:2048
    ds_read_b64_tr_b16 a[206:207], v13 offset:2560
    s_waitcnt vmcnt(20)
    v_mfma_f32_32x32x16_bf16 v[64:79], a[104:107], v[168:171], v[64:79]
    v_mfma_f32_32x32x16_bf16 v[96:111], a[108:111], v[168:171], v[96:111]
    buffer_load_dwordx4 v[168:171], v16, s[28:31], s59 offen
    v_mfma_f32_32x32x16_bf16 v[80:95], a[104:107], v[172:175], v[80:95]
    v_mfma_f32_32x32x16_bf16 v[112:127], a[108:111], v[172:175], v[112:127]
    buffer_load_dwordx4 v[172:175], v17, s[28:31], s59 offen
    s_add_u32 s59, s59, 1024
    s_and_b32 s59, s59, 0x7fff
    s_waitcnt lgkmcnt(0)
    ds_read_b64_tr_b16 a[208:209], v12 offset:4096
    ds_read_b64_tr_b16 a[210:211], v12 offset:4608
    ds_read_b64_tr_b16 a[212:213], v13 offset:4096
    ds_read_b64_tr_b16 a[214:215], v13 offset:4608
    s_waitcnt vmcnt(18)
    v_mfma_f32_32x32x16_bf16 v[64:79], a[112:115], v[176:179], v[64:79]
    v_mfma_f32_32x32x16_bf16 v[96:111], a[116:119], v[176:179], v[96:111]
    buffer_load_dwordx4 v[176:179], v16, s[28:31], s59 offen
    v_mfma_f32_32x32x16_bf16 v[80:95], a[112:115], v[180:183], v[80:95]
    v_mfma_f32_32x32x16_bf16 v[112:127], a[116:119], v[180:183], v[112:127]
    buffer_load_dwordx4 v[180:183], v17, s[28:31], s59 offen
    s_add_u32 s59, s59, 1024
    s_and_b32 s59, s59, 0x7fff
    s_waitcnt lgkmcnt(0)
    ds_read_b64_tr_b16 a[216:217], v12 offset:6144
    ds_read_b64_tr_b16 a[218:219], v12 offset:6656
    ds_read_b64_tr_b16 a[220:221], v13 offset:6144
    ds_read_b64_tr_b16 a[222:223], v13 offset:6656
    s_waitcnt vmcnt(16)
    v_mfma_f32_32x32x16_bf16 v[64:79], a[120:123], v[184:187], v[64:79]
    v_mfma_f32_32x32x16_bf16 v[96:111], a[124:127], v[184:187], v[96:111]
    buffer_load_dwordx4 v[184:187], v16, s[28:31], s59 offen
    v_mfma_f32_32x32x16_bf16 v[80:95], a[120:123], v[188:191], v[80:95]
    v_mfma_f32_32x32x16_bf16 v[112:127], a[124:127], v[188:191], v[112:127]
    buffer_load_dwordx4 v[188:191], v17, s[28:31], s59 offen
    s_add_u32 s59, s59, 1024
    s_and_b32 s59, s59, 0x7fff
    s_waitcnt lgkmcnt(0)
    ds_read_b64_tr_b16 a[224:225], v12 offset:8192
    ds_read_b64_tr_b16 a[226:227], v12 offset:8704
    ds_read_b64_tr_b16 a[228:229], v13 offset:8192
    ds_read_b64_tr_b16 a[230:231], v13 offset:8704
    s_waitcnt vmcnt(14)
    v_mfma_f32_32x32x16_bf16 v[64:79], a[128:131], v[128:131], v[64:79]
    v_mfma_f32_32x32x16_bf16 v[96:111], a[132:135], v[128:131], v[96:111]
    buffer_load_dwordx4 v[128:131], v16, s[28:31], s59 offen
    v_mfma_f32_32x32x16_bf16 v[80:95], a[128:131], v[132:135], v[80:95]
    v_mfma_f32_32x32x16_bf16 v[112:127], a[132:135], v[132:135], v[112:127]
    buffer_load_dwordx4 v[132:135], v17, s[28:31], s59 offen
    s_add_u32 s59, s59, 1024
    s_and_b32 s59, s59, 0x7fff
    s_waitcnt lgkmcnt(0)
    ds_read_b64_tr_b16 a[232:233], v12 offset:10240
    ds_read_b64_tr_b16 a[234:235], v12 offset:10752
    ds_read_b64_tr_b16 a[236:237], v13 offset:10240
    ds_read_b64_tr_b16 a[238:239], v13 offset:10752
    s_waitcnt vmcnt(14)
    v_mfma_f32_32x32x16_bf16 v[64:79], a[136:139], v[136:139], v[64:79]
    v_mfma_f32_32x32x16_bf16 v[96:111], a[140:143], v[136:139], v[96:111]
    buffer_load_dwordx4 v[136:139], v16, s[28:31], s59 offen
    v_mfma_f32_32x32x16_bf16 v[80:95], a[136:139], v[140:143], v[80:95]
    v_mfma_f32_32x32x16_bf16 v[112:127], a[140:143], v[140:143], v[112:127]
    buffer_load_dwordx4 v[140:143], v17, s[28:31], s59 offen
    s_add_u32 s59, s59, 1024
    s_and_b32 s59, s59, 0x7fff
    s_waitcnt lgkmcnt(0)
    ds_read_b64_tr_b16 a[240:241], v12 offset:12288
    ds_read_b64_tr_b16 a[242:243], v12 offset:12800
    ds_read_b64_tr_b16 a[244:245], v13 offset:12288
    ds_read_b64_tr_b16 a[246:247], v13 offset:12800
    s_waitcnt vmcnt(14)
    v_mfma_f32_32x32x16_bf16 v[64:79], a[144:147], v[144:147], v[64:79]
    v_mfma_f32_32x32x16_bf16 v[96:111], a[148:151], v[144:147], v[96:111]
    buffer_load_dwordx4 v[144:147], v16, s[28:31], s59 offen
    v_mfma_f32_32x32x16_bf16 v[80:95], a[144:147], v[148:151], v[80:95]
    v_mfma_f32_32x32x16_bf16 v[112:127], a[148:151], v[148:151], v[112:127]
    buffer_load_dwordx4 v[148:151], v17, s[28:31], s59 offen
    s_add_u32 s59, s59, 1024
    s_and_b32 s59, s59, 0x7fff
    s_waitcnt lgkmcnt(0)
    ds_read_b64_tr_b16 a[248:249], v12 offset:14336
    ds_read_b64_tr_b16 a[250:251], v12 offset:14848
    ds_read_b64_tr_b16 a[252:253], v13 offset:14336
    ds_read_b64_tr_b16 a[254:255], v13 offset:14848
    s_waitcnt vmcnt(14)
    v_mfma_f32_32x32x16_bf16 v[64:79], a[152:155], v[152:155], v[64:79]
    v_mfma_f32_32x32x16_bf16 v[96:111], a[156:159], v[152:155], v[96:111]
    buffer_load_dwordx4 v[152:155], v16, s[28:31], s59 offen
    v_mfma_f32_32x32x16_bf16 v[80:95], a[152:155], v[156:159], v[80:95]
    v_mfma_f32_32x32x16_bf16 v[112:127], a[156:159], v[156:159], v[112:127]
    buffer_load_dwordx4 v[156:159], v17, s[28:31], s59 offen
    s_add_u32 s59, s59, 1024
    s_and_b32 s59, s59, 0x7fff
    s_waitcnt lgkmcnt(0)
    s_waitcnt vmcnt(14)
    v_mfma_f32_32x32x16_bf16 v[64:79], a[160:163], v[160:163], v[64:79]
    v_mfma_f32_32x32x16_bf16 v[96:111], a[164:167], v[160:163], v[96:111]
    buffer_load_dwordx4 v[160:163], v16, s[28:31], s59 offen
    v_mfma_f32_32x32x16_bf16 v[80:95], a[160:163], v[164:167], v[80:95]
    v_mfma_f32_32x32x16_bf16 v[112:127], a[164:167], v[164:167], v[112:127]
    buffer_load_dwordx4 v[164:167], v17, s[28:31], s59 offen
    s_add_u32 s59, s59, 1024
    s_and_b32 s59, s59, 0x7fff
    s_waitcnt vmcnt(14)
    v_mfma_f32_32x32x16_bf16 v[64:79], a[168:171], v[168:171], v[64:79]
    v_mfma_f32_32x32x16_bf16 v[96:111], a[172:175], v[168:171], v[96:111]
    buffer_load_dwordx4 v[168:171], v16, s[28:31], s59 offen
    v_mfma_f32_32x32x16_bf16 v[80:95], a[168:171], v[172:175], v[80:95]
    v_mfma_f32_32x32x16_bf16 v[112:127], a[172:175], v[172:175], v[112:127]
    buffer_load_dwordx4 v[172:175], v17, s[28:31], s59 offen
    s_add_u32 s59, s59, 1024
    s_and_b32 s59, s59, 0x7fff
    s_waitcnt vmcnt(14)
    v_mfma_f32_32x32x16_bf16 v[64:79], a[176:179], v[176:179], v[64:79]
    v_mfma_f32_32x32x16_bf16 v[96:111], a[180:183], v[176:179], v[96:111]
    buffer_load_dwordx4 v[176:179], v16, s[28:31], s59 offen
    v_mfma_f32_32x32x16_bf16 v[80:95], a[176:179], v[180:183], v[80:95]
    v_mfma_f32_32x32x16_bf16 v[112:127], a[180:183], v[180:183], v[112:127]
    buffer_load_dwordx4 v[180:183], v17, s[28:31], s59 offen
    s_add_u32 s59, s59, 1024
    s_and_b32 s59, s59, 0x7fff
    s_waitcnt vmcnt(14)
    v_mfma_f32_32x32x16_bf16 v[64:79], a[184:187], v[184:187], v[64:79]
    v_mfma_f32_32x32x16_bf16 v[96:111], a[188:191], v[184:187], v[96:111]
    buffer_load_dwordx4 v[184:187], v16, s[28:31], s59 offen
    v_mfma_f32_32x32x16_bf16 v[80:95], a[184:187], v[188:191], v[80:95]
    v_mfma_f32_32x32x16_bf16 v[112:127], a[188:191], v[188:191], v[112:127]
    buffer_load_dwordx4 v[188:191], v17, s[28:31], s59 offen
    s_add_u32 s59, s59, 1024
    s_and_b32 s59, s59, 0x7fff
    s_waitcnt vmcnt(14)
    v_mfma_f32_32x32x16_bf16 v[64:79], a[192:195], v[128:131], v[64:79]
    v_mfma_f32_32x32x16_bf16 v[80:95], a[192:195], v[132:135], v[80:95]
    v_mfma_f32_32x32x16_bf16 v[96:111], a[196:199], v[128:131], v[96:111]
    v_mfma_f32_32x32x16_bf16 v[112:127], a[196:199], v[132:135], v[112:127]
    s_waitcnt vmcnt(12)
    v_mfma_f32_32x32x16_bf16 v[64:79], a[200:203], v[136:139], v[64:79]
    v_mfma_f32_32x32x16_bf16 v[80:95], a[200:203], v[140:143], v[80:95]
    v_mfma_f32_32x32x16_bf16 v[96:111], a[204:207], v[136:139], v[96:111]
    v_mfma_f32_32x32x16_bf16 v[112:127], a[204:207], v[140:143], v[112:127]
    s_waitcnt vmcnt(10)
    v_mfma_f32_32x32x16_bf16 v[64:79], a[208:211], v[144:147], v[64:79]
    v_mfma_f32_32x32x16_bf16 v[80:95], a[208:211], v[148:151], v[80:95]
    v_mfma_f32_32x32x16_bf16 v[96:111], a[212:215], v[144:147], v[96:111]
    v_mfma_f32_32x32x16_bf16 v[112:127], a[212:215], v[148:151], v[112:127]
    s_waitcnt vmcnt(8)
    v_mfma_f32_32x32x16_bf16 v[64:79], a[216:219], v[152:155], v[64:79]
    v_mfma_f32_32x32x16_bf16 v[80:95], a[216:219], v[156:159], v[80:95]
    v_mfma_f32_32x32x16_bf16 v[96:111], a[220:223], v[152:155], v[96:111]
    v_mfma_f32_32x32x16_bf16 v[112:127], a[220:223], v[156:159], v[112:127]
    s_waitcnt vmcnt(6)
    v_mfma_f32_32x32x16_bf16 v[64:79], a[224:227], v[160:163], v[64:79]
    v_mfma_f32_32x32x16_bf16 v[80:95], a[224:227], v[164:167], v[80:95]
    v_mfma_f32_32x32x16_bf16 v[96:111], a[228:231], v[160:163], v[96:111]
    v_mfma_f32_32x32x16_bf16 v[112:127], a[228:231], v[164:167], v[112:127]
    s_waitcnt vmcnt(4)
    v_mfma_f32_32x32x16_bf16 v[64:79], a[232:235], v[168:171], v[64:79]
    v_mfma_f32_32x32x16_bf16 v[80:95], a[232:235], v[172:175], v[80:95]
    v_mfma_f32_32x32x16_bf16 v[96:111], a[236:239], v[168:171], v[96:111]
    v_mfma_f32_32x32x16_bf16 v[112:127], a[236:239], v[172:175], v[112:127]
    s_waitcnt vmcnt(2)
    v_mfma_f32_32x32x16_bf16 v[64:79], a[240:243], v[176:179], v[64:79]
    v_mfma_f32_32x32x16_bf16 v[80:95], a[240:243], v[180:183], v[80:95]
    v_mfma_f32_32x32x16_bf16 v[96:111], a[244:247], v[176:179], v[96:111]
    v_mfma_f32_32x32x16_bf16 v[112:127], a[244:247], v[180:183], v[112:127]
    s_waitcnt vmcnt(0)
    v_mfma_f32_32x32x16_bf16 v[64:79], a[248:251], v[184:187], v[64:79]
    v_mfma_f32_32x32x16_bf16 v[80:95], a[248:251], v[188:191], v[80:95]
    v_mfma_f32_32x32x16_bf16 v[96:111], a[252:255], v[184:187], v[96:111]
    v_mfma_f32_32x32x16_bf16 v[112:127], a[252:255], v[188:191], v[112:127]
    s_mov_b32 s32, s8
    s_and_b32 s33, s9, 0xffff
    s_mov_b32 s34, 0x80000
    s_mov_b32 s35, 0x20000
    s_mov_b32 s36, s16
    s_and_b32 s37, s17, 0xffff
    s_mov_b32 s38, 0x560000
    s_mov_b32 s39, 0x20000
    s_lshr_b32 s56, s26, 1
    s_and_b32 s57, s26, 1
    s_mul_i32 s58, s26, 24576
    v_lshrrev_b32 v2, 3, v1
    v_and_b32 v3, 7, v1
    v_bfe_u32 v4, v1, 4, 1
    v_lshlrev_b32 v4, 2, v4
    v_xor_b32 v3, v3, v4
    s_mov_b32 s48, 1024
    v_mul_lo_u32 v2, v2, s48
    v_lshl_add_u32 v10, v3, 4, v2
    v_lshrrev_b32 v2, 3, v1
    v_and_b32 v3, 7, v1
    v_bfe_u32 v4, v1, 4, 1
    v_lshlrev_b32 v4, 2, v4
    v_xor_b32 v3, v3, v4
    s_mov_b32 s48, 4096
    v_mul_lo_u32 v2, v2, s48
    v_lshl_add_u32 v9, v3, 4, v2
    v_lshlrev_b32 v11, 4, v1
    v_bfe_u32 v2, v1, 2, 2
    v_lshrrev_b32 v3, 5, v1
    v_bfe_u32 v4, v1, 4, 1
    v_and_b32 v5, 3, v1
    v_lshl_add_u32 v6, v3, 3, v2
    v_lshlrev_b32 v6, 7, v6
    v_lshrrev_b32 v7, 1, v2
    v_xor_b32 v7, s56, v7
    v_lshl_add_u32 v6, v7, 6, v6
    v_lshl_add_u32 v6, v4, 5, v6
    v_lshrrev_b32 v7, 1, v5
    v_lshl_add_u32 v6, v7, 4, v6
    v_and_b32 v7, 1, v5
    v_lshl_add_u32 v6, v7, 3, v6
    v_add_u32 v12, s58, v6
    v_xor_b32 v13, 64, v12
    v_bfe_u32 v2, v1, 2, 2
    v_lshrrev_b32 v3, 5, v1
    v_bfe_u32 v4, v1, 4, 1
    v_and_b32 v5, 3, v1
    v_lshl_add_u32 v6, v3, 2, v2
    v_lshlrev_b32 v6, 7, v6
    v_lshrrev_b32 v7, 1, v2
    v_xor_b32 v7, s57, v7
    v_lshl_add_u32 v6, v7, 6, v6
    v_lshl_add_u32 v6, v4, 5, v6
    v_lshrrev_b32 v7, 1, v5
    v_lshl_add_u32 v6, v7, 4, v6
    v_and_b32 v7, 1, v5
    v_lshl_add_u32 v6, v7, 3, v6
    v_add_u32 v18, s58, v6
    v_xor_b32 v19, 64, v18
    s_lshl_b32 s60, s79, 7
    s_mul_i32 s48, s26, 131072
    s_add_u32 s60, s60, s48
    s_lshl_b32 s66, s78, 7
    s_mul_i32 s48, s26, 1441792
    s_add_u32 s66, s66, s48
    s_lshl_b32 s62, s78, 1
    s_add_u32 s62, s62, s57
    s_xor_b32 s63, s62, 1
    s_lshl_b32 s62, s62, 15
    s_lshl_b32 s63, s63, 15
    s_lshl_b32 s48, s26, 13
    s_add_u32 s48, s48, 0x400000
    s_add_u32 s62, s62, s48
    s_add_u32 s63, s63, s48
    s_lshl_b32 s68, s79, 1
    s_add_u32 s68, s68, s56
    s_xor_b32 s69, s68, 1
    s_mul_i32 s68, s68, 90112
    s_mul_i32 s69, s69, 90112
    s_mul_i32 s48, s26, 22528
    s_add_u32 s48, s48, 0x200000
    s_add_u32 s68, s68, s48
    s_add_u32 s69, s69, s48
    s_and_b32 s48, s78, 7
    s_and_b32 s49, s79, 3
    s_mul_i32 s64, s49, 5
    s_mul_i32 s65, s48, 3
    s_add_u32 s64, s64, s65
    s_sub_u32 s65, s64, 22
    s_cmp_ge_u32 s64, 22
    s_cselect_b32 s64, s65, s64
    s_lshl_b32 s65, s49, 1
    s_add_u32 s65, s65, s48
    s_lshl_b32 s67, s64, 16
    s_add_u32 s67, s67, s66
    s_add_u32 s61, s66, 1441792
    v_add_u32 v27, 32768, v9
    s_add_u32 m0, s58, 0
    s_add_u32 s48, s67, 65536
    buffer_load_dwordx4 v9, s[36:39], s67 offen lds
    s_add_u32 m0, s58, 1024
    s_cmp_eq_u32 s48, s61
    buffer_load_dwordx4 v27, s[36:39], s67 offen lds
    s_cselect_b32 s67, s66, s48
    s_add_u32 m0, s58, 2048
    s_add_u32 s48, s67, 65536
    buffer_load_dwordx4 v9, s[36:39], s67 offen lds
    s_add_u32 m0, s58, 3072
    s_cmp_eq_u32 s48, s61
    buffer_load_dwordx4 v27, s[36:39], s67 offen lds
    s_cselect_b32 s67, s66, s48
    s_add_u32 m0, s58, 4096
    s_add_u32 s48, s67, 65536
    buffer_load_dwordx4 v9, s[36:39], s67 offen lds
    s_add_u32 m0, s58, 5120
    s_cmp_eq_u32 s48, s61
    buffer_load_dwordx4 v27, s[36:39], s67 offen lds
    s_cselect_b32 s67, s66, s48
    s_add_u32 m0, s58, 6144
    s_add_u32 s48, s67, 65536
    buffer_load_dwordx4 v9, s[36:39], s67 offen lds
    s_add_u32 m0, s58, 7168
    s_cmp_eq_u32 s48, s61
    buffer_load_dwordx4 v27, s[36:39], s67 offen lds
    s_cselect_b32 s67, s66, s48
    s_add_u32 m0, s58, 8192
    s_add_u32 s48, s67, 65536
    buffer_load_dwordx4 v9, s[36:39], s67 offen lds
    s_add_u32 m0, s58, 9216
    s_cmp_eq_u32 s48, s61
    buffer_load_dwordx4 v27, s[36:39], s67 offen lds
    s_cselect_b32 s67, s66, s48
    s_add_u32 m0, s58, 10240
    s_add_u32 s48, s67, 65536
    buffer_load_dwordx4 v9, s[36:39], s67 offen lds
    s_add_u32 m0, s58, 11264
    s_cmp_eq_u32 s48, s61
    buffer_load_dwordx4 v27, s[36:39], s67 offen lds
    s_cselect_b32 s67, s66, s48
    s_mul_i32 s48, s26, 12288
    s_add_u32 s48, s48, 98304
    v_add_u32 v14, s48, v11
    s_xor_b32 s48, s26, 1
    s_mul_i32 s48, s48, 12288
    s_add_u32 s48, s48, 98304
    v_add_u32 v15, s48, v11
    s_xor_b32 s48, s26, 2
    s_mul_i32 s48, s48, 12288
    s_add_u32 s48, s48, 102400
    v_add_u32 v16, s48, v11
    s_xor_b32 s48, s26, 3
    s_mul_i32 s48, s48, 12288
    s_add_u32 s48, s48, 106496
    v_add_u32 v17, s48, v11
    s_nop 7
    ds_write_b128 v14, v[80:83] offset:0
    ds_write_b128 v14, v[84:87] offset:1024
    ds_write_b128 v14, v[88:91] offset:2048
    ds_write_b128 v14, v[92:95] offset:3072
    ds_write_b128 v14, v[96:99] offset:4096
    ds_write_b128 v14, v[100:103] offset:5120
    ds_write_b128 v14, v[104:107] offset:6144
    ds_write_b128 v14, v[108:111] offset:7168
    s_nop 3
    ds_write_b128 v14, v[112:115] offset:8192
    ds_write_b128 v14, v[116:119] offset:9216
    ds_write_b128 v14, v[120:123] offset:10240
    ds_write_b128 v14, v[124:127] offset:11264
    s_waitcnt lgkmcnt(0)
    s_barrier
    ds_read_b128 v[128:131], v15 offset:0
    ds_read_b128 v[132:135], v15 offset:1024
    ds_read_b128 v[136:139], v15 offset:2048
    ds_read_b128 v[140:143], v15 offset:3072
    ds_read_b128 v[144:147], v16 offset:0
    ds_read_b128 v[148:151], v16 offset:1024
    ds_read_b128 v[152:155], v16 offset:2048
    ds_read_b128 v[156:159], v16 offset:3072
    ds_read_b128 v[160:163], v17 offset:0
    ds_read_b128 v[164:167], v17 offset:1024
    ds_read_b128 v[168:171], v17 offset:2048
    ds_read_b128 v[172:175], v17 offset:3072
    s_waitcnt lgkmcnt(8)
    v_pk_add_f32 v[64:65], v[64:65], v[128:129]
    v_pk_add_f32 v[66:67], v[66:67], v[130:131]
    v_pk_add_f32 v[68:69], v[68:69], v[132:133]
    v_pk_add_f32 v[70:71], v[70:71], v[134:135]
    v_pk_add_f32 v[72:73], v[72:73], v[136:137]
    v_pk_add_f32 v[74:75], v[74:75], v[138:139]
    v_pk_add_f32 v[76:77], v[76:77], v[140:141]
    v_pk_add_f32 v[78:79], v[78:79], v[142:143]
    s_waitcnt lgkmcnt(4)
    v_pk_add_f32 v[64:65], v[64:65], v[144:145]
    v_pk_add_f32 v[66:67], v[66:67], v[146:147]
    v_pk_add_f32 v[68:69], v[68:69], v[148:149]
    v_pk_add_f32 v[70:71], v[70:71], v[150:151]
    v_pk_add_f32 v[72:73], v[72:73], v[152:153]
    v_pk_add_f32 v[74:75], v[74:75], v[154:155]
    v_pk_add_f32 v[76:77], v[76:77], v[156:157]
    v_pk_add_f32 v[78:79], v[78:79], v[158:159]
    s_waitcnt lgkmcnt(0)
    v_pk_add_f32 v[64:65], v[64:65], v[160:161]
    v_pk_add_f32 v[66:67], v[66:67], v[162:163]
    v_pk_add_f32 v[68:69], v[68:69], v[164:165]
    v_pk_add_f32 v[70:71], v[70:71], v[166:167]
    v_pk_add_f32 v[72:73], v[72:73], v[168:169]
    v_pk_add_f32 v[74:75], v[74:75], v[170:171]
    v_pk_add_f32 v[76:77], v[76:77], v[172:173]
    v_pk_add_f32 v[78:79], v[78:79], v[174:175]
    v_lshlrev_b32 v128, 16, v40
    v_and_b32 v129, 0xffff0000, v40
    v_lshlrev_b32 v130, 16, v41
    v_and_b32 v131, 0xffff0000, v41
    v_lshlrev_b32 v132, 16, v42
    v_and_b32 v133, 0xffff0000, v42
    v_lshlrev_b32 v134, 16, v43
    v_and_b32 v135, 0xffff0000, v43
    v_lshlrev_b32 v136, 16, v44
    v_and_b32 v137, 0xffff0000, v44
    v_lshlrev_b32 v138, 16, v45
    v_and_b32 v139, 0xffff0000, v45
    v_lshlrev_b32 v140, 16, v46
    v_and_b32 v141, 0xffff0000, v46
    v_lshlrev_b32 v142, 16, v47
    v_and_b32 v143, 0xffff0000, v47
    v_pk_add_f32 v[64:65], v[64:65], v[128:129]
    v_pk_add_f32 v[66:67], v[66:67], v[130:131]
    v_pk_add_f32 v[68:69], v[68:69], v[132:133]
    v_pk_add_f32 v[70:71], v[70:71], v[134:135]
    v_pk_add_f32 v[72:73], v[72:73], v[136:137]
    v_pk_add_f32 v[74:75], v[74:75], v[138:139]
    v_pk_add_f32 v[76:77], v[76:77], v[140:141]
    v_pk_add_f32 v[78:79], v[78:79], v[142:143]
    s_mov_b32 s48, 0xbdd2d3e8
    s_mov_b32 s49, 0xbdd2d3e8
    v_mov_b32 v144, 0xc0135761
    v_mov_b32 v145, 0xc0135761
    v_pk_mul_f32 v[128:129], v[64:65], v[64:65]
    v_pk_fma_f32 v[128:129], v[128:129], s[48:49], v[144:145]
    v_pk_mul_f32 v[128:129], v[128:129], v[64:65]
    v_pk_mul_f32 v[130:131], v[66:67], v[66:67]
    v_pk_fma_f32 v[130:131], v[130:131], s[48:49], v[144:145]
    v_pk_mul_f32 v[130:131], v[130:131], v[66:67]
    v_pk_mul_f32 v[132:133], v[68:69], v[68:69]
    v_pk_fma_f32 v[132:133], v[132:133], s[48:49], v[144:145]
    v_pk_mul_f32 v[132:133], v[132:133], v[68:69]
    v_pk_mul_f32 v[134:135], v[70:71], v[70:71]
    v_pk_fma_f32 v[134:135], v[134:135], s[48:49], v[144:145]
    v_pk_mul_f32 v[134:135], v[134:135], v[70:71]
    v_pk_mul_f32 v[136:137], v[72:73], v[72:73]
    v_pk_fma_f32 v[136:137], v[136:137], s[48:49], v[144:145]
    v_pk_mul_f32 v[136:137], v[136:137], v[72:73]
    v_pk_mul_f32 v[138:139], v[74:75], v[74:75]
    v_pk_fma_f32 v[138:139], v[138:139], s[48:49], v[144:145]
    v_pk_mul_f32 v[138:139], v[138:139], v[74:75]
    v_pk_mul_f32 v[140:141], v[76:77], v[76:77]
    v_pk_fma_f32 v[140:141], v[140:141], s[48:49], v[144:145]
    v_pk_mul_f32 v[140:141], v[140:141], v[76:77]
    v_pk_mul_f32 v[142:143], v[78:79], v[78:79]
    v_pk_fma_f32 v[142:143], v[142:143], s[48:49], v[144:145]
    v_pk_mul_f32 v[142:143], v[142:143], v[78:79]
    v_exp_f32 v128, v128
    v_exp_f32 v129, v129
    v_exp_f32 v130, v130
    v_exp_f32 v131, v131
    v_exp_f32 v132, v132
    v_exp_f32 v133, v133
    v_exp_f32 v134, v134
    v_exp_f32 v135, v135
    v_exp_f32 v136, v136
    v_exp_f32 v137, v137
    v_exp_f32 v138, v138
    v_exp_f32 v139, v139
    v_exp_f32 v140, v140
    v_exp_f32 v141, v141
    v_exp_f32 v142, v142
    v_exp_f32 v143, v143
    s_nop 0
    v_pk_add_f32 v[128:129], v[128:129], 1.0 op_sel_hi:[1,0]
    v_pk_add_f32 v[130:131], v[130:131], 1.0 op_sel_hi:[1,0]
    v_pk_add_f32 v[132:133], v[132:133], 1.0 op_sel_hi:[1,0]
    v_pk_add_f32 v[134:135], v[134:135], 1.0 op_sel_hi:[1,0]
    v_pk_add_f32 v[136:137], v[136:137], 1.0 op_sel_hi:[1,0]
    v_pk_add_f32 v[138:139], v[138:139], 1.0 op_sel_hi:[1,0]
    v_pk_add_f32 v[140:141], v[140:141], 1.0 op_sel_hi:[1,0]
    v_pk_add_f32 v[142:143], v[142:143], 1.0 op_sel_hi:[1,0]
    v_rcp_f32 v128, v128
    v_rcp_f32 v129, v129
    v_rcp_f32 v130, v130
    v_rcp_f32 v131, v131
    v_rcp_f32 v132, v132
    v_rcp_f32 v133, v133
    v_rcp_f32 v134, v134
    v_rcp_f32 v135, v135
    v_rcp_f32 v136, v136
    v_rcp_f32 v137, v137
    v_rcp_f32 v138, v138
    v_rcp_f32 v139, v139
    v_rcp_f32 v140, v140
    v_rcp_f32 v141, v141
    v_rcp_f32 v142, v142
    v_rcp_f32 v143, v143
    s_nop 0
    v_pk_mul_f32 v[64:65], v[64:65], v[128:129]
    v_pk_mul_f32 v[66:67], v[66:67], v[130:131]
    v_pk_mul_f32 v[68:69], v[68:69], v[132:133]
    v_pk_mul_f32 v[70:71], v[70:71], v[134:135]
    v_pk_mul_f32 v[72:73], v[72:73], v[136:137]
    v_pk_mul_f32 v[74:75], v[74:75], v[138:139]
    v_pk_mul_f32 v[76:77], v[76:77], v[140:141]
    v_pk_mul_f32 v[78:79], v[78:79], v[142:143]
    v_cvt_pk_bf16_f32 v128, v64, v65
    v_cvt_pk_bf16_f32 v129, v66, v67
    v_cvt_pk_bf16_f32 v130, v68, v69
    v_cvt_pk_bf16_f32 v131, v70, v71
    v_cvt_pk_bf16_f32 v132, v72, v73
    v_cvt_pk_bf16_f32 v133, v74, v75
    v_cvt_pk_bf16_f32 v134, v76, v77
    v_cvt_pk_bf16_f32 v135, v78, v79
    s_lshl_b32 s48, s76, 1
    s_add_u32 s48, s48, s56
    s_cmp_lt_u32 s48, 43
    s_cbranch_scc1 Lz_13
    v_mov_b32 v128, 0
    v_mov_b32 v129, 0
    v_mov_b32 v130, 0
    v_mov_b32 v131, 0
    v_mov_b32 v132, 0
    v_mov_b32 v133, 0
    v_mov_b32 v134, 0
    v_mov_b32 v135, 0
Lz_13:
    s_lshl_b32 s49, s77, 1
    s_add_u32 s49, s49, s57
    s_mul_i32 s49, s49, 88
    s_lshl_b32 s48, s48, 1
    s_add_u32 s49, s49, s48
    s_lshl_b32 s49, s49, 10
    s_add_u32 s49, s49, 0x200000
    buffer_store_dwordx4 v[128:131], v11, s[28:31], s49 offen sc1
    buffer_store_dwordx4 v[132:135], v11, s[28:31], s49 offen offset:1024 sc1
    s_lshl_b32 s48, s76, 3
    s_add_u32 s48, s48, s77
    s_mul_i32 s48, s48, 64
    s_add_u32 s73, s48, 0x702000
    s_waitcnt vmcnt(2)
    ds_read_b64_tr_b16 a[0:1], v18 offset:0
    ds_read_b64_tr_b16 a[2:3], v18 offset:1024
    ds_read_b64_tr_b16 a[4:5], v19 offset:0
    ds_read_b64_tr_b16 a[6:7], v19 offset:1024
    ds_read_b64_tr_b16 a[8:9], v18 offset:2048
    ds_read_b64_tr_b16 a[10:11], v18 offset:3072
    ds_read_b64_tr_b16 a[12:13], v19 offset:2048
    ds_read_b64_tr_b16 a[14:15], v19 offset:3072
    s_waitcnt lgkmcnt(4)
    ds_read_b64_tr_b16 a[16:17], v18 offset:4096
    ds_read_b64_tr_b16 a[18:19], v18 offset:5120
    ds_read_b64_tr_b16 a[20:21], v19 offset:4096
    ds_read_b64_tr_b16 a[22:23], v19 offset:5120
    ds_read_b64_tr_b16 a[24:25], v18 offset:6144
    ds_read_b64_tr_b16 a[26:27], v18 offset:7168
    ds_read_b64_tr_b16 a[28:29], v19 offset:6144
    ds_read_b64_tr_b16 a[30:31], v19 offset:7168
    s_waitcnt lgkmcnt(4)
    ds_read_b64_tr_b16 a[32:33], v18 offset:8192
    ds_read_b64_tr_b16 a[34:35], v18 offset:9216
    ds_read_b64_tr_b16 a[36:37], v19 offset:8192
    ds_read_b64_tr_b16 a[38:39], v19 offset:9216
    ds_read_b64_tr_b16 a[40:41], v18 offset:10240
    ds_read_b64_tr_b16 a[42:43], v18 offset:11264
    ds_read_b64_tr_b16 a[44:45], v19 offset:10240
    ds_read_b64_tr_b16 a[46:47], v19 offset:11264
    s_waitcnt lgkmcnt(4)
    s_waitcnt lgkmcnt(0)
    s_add_u32 m0, s58, 12288
    s_add_u32 s48, s67, 65536
    buffer_load_dwordx4 v9, s[36:39], s67 offen lds
    s_add_u32 m0, s58, 13312
    s_cmp_eq_u32 s48, s61
    buffer_load_dwordx4 v27, s[36:39], s67 offen lds
    s_cselect_b32 s67, s66, s48
    s_add_u32 m0, s58, 14336
    s_add_u32 s48, s67, 65536
    buffer_load_dwordx4 v9, s[36:39], s67 offen lds
    s_add_u32 m0, s58, 15360
    s_cmp_eq_u32 s48, s61
    buffer_load_dwordx4 v27, s[36:39], s67 offen lds
    s_cselect_b32 s67, s66, s48
    s_add_u32 m0, s58, 16384
    s_add_u32 s48, s67, 65536
    buffer_load_dwordx4 v9, s[36:39], s67 offen lds
    s_add_u32 m0, s58, 17408
    s_cmp_eq_u32 s48, s61
    buffer_load_dwordx4 v27, s[36:39], s67 offen lds
    s_cselect_b32 s67, s66, s48
    s_add_u32 m0, s58, 18432
    s_add_u32 s48, s67, 65536
    buffer_load_dwordx4 v9, s[36:39], s67 offen lds
    s_add_u32 m0, s58, 19456
    s_cmp_eq_u32 s48, s61
    buffer_load_dwordx4 v27, s[36:39], s67 offen lds
    s_cselect_b32 s67, s66, s48
    s_add_u32 m0, s58, 20480
    s_add_u32 s48, s67, 65536
    buffer_load_dwordx4 v9, s[36:39], s67 offen lds
    s_add_u32 m0, s58, 21504
    s_cmp_eq_u32 s48, s61
    buffer_load_dwordx4 v27, s[36:39], s67 offen lds
    s_cselect_b32 s67, s66, s48
    s_add_u32 m0, s58, 22528
    s_add_u32 s48, s67, 65536
    buffer_load_dwordx4 v9, s[36:39], s67 offen lds
    s_add_u32 m0, s58, 23552
    s_cmp_eq_u32 s48, s61
    buffer_load_dwordx4 v27, s[36:39], s67 offen lds
    s_cselect_b32 s67, s66, s48
    s_waitcnt vmcnt(12)
    s_barrier
    s_cmp_lg_u32 s26, 0
    s_cbranch_scc1 Lf_14
    v_mov_b32 v4, s74
    v_mov_b32 v5, s75
    v_mov_b32 v2, 0
    s_mov_b64 exec, 1
    buffer_store_dwordx2 v[4:5], v2, s[28:31], s73 offen sc1
    s_mov_b64 exec, -1
Lf_14:
    s_mov_b32 s40, s4
    s_and_b32 s41, s5, 0xffff
    s_mov_b32 s42, 0x200000
    s_mov_b32 s43, 0x20000
    s_mov_b32 s44, s18
    s_and_b32 s45, s19, 0xffff
    s_mov_b32 s46, 0x1000
    s_mov_b32 s47, 0x20000
    v_and_b32 v2, 31, v1
    v_lshlrev_b32 v3, 10, v2
    v_lshrrev_b32 v4, 5, v1
    v_lshl_add_u32 v8, v4, 3, v3
    s_lshl_b32 s70, s78, 6
    s_lshl_b32 s48, s57, 5
    s_add_u32 s70, s70, s48
    s_lshl_b32 s71, s70, 10
    s_lshl_b32 s48, s79, 7
    s_add_u32 s71, s71, s48
    s_lshl_b32 s48, s56, 6
    s_add_u32 s71, s71, s48
    buffer_load_dwordx2 v[40:41], v8, s[40:43], s71 offen offset:0
    buffer_load_dwordx2 v[42:43], v8, s[40:43], s71 offen offset:16
    buffer_load_dwordx2 v[44:45], v8, s[40:43], s71 offen offset:32
    buffer_load_dwordx2 v[46:47], v8, s[40:43], s71 offen offset:48
    v_lshlrev_b32 v2, 1, v2
    s_lshl_b32 s72, s70, 1
    buffer_load_ushort v48, v2, s[44:47], s72 offen
    s_mul_i32 s48, s26, 352
    s_lshr_b32 s49, s48, 6
    s_add_u32 s50, s48, 351
    s_lshr_b32 s50, s50, 6
    s_min_u32 s50, s50, 21
    v_add_u32 v2, s49, v1
    v_min_u32 v2, s50, v2
    v_lshlrev_b32 v2, 3, v2
    v_add_u32 v2, s79, v2
    v_mul_u32_u24 v2, 64, v2
    v_add_u32 v20, 0x702000, v2
    s_lshl_b32 s48, s78, 6
    s_mul_hi_u32 s49, s48, 0x13b13b2
    s_add_u32 s48, s48, 63
    s_mul_hi_u32 s50, s48, 0x13b13b2
    v_and_b32 v2, 1, v1
    v_bfe_u32 v3, v1, 1, 1
    v_mov_b32 v4, s49
    v_mov_b32 v5, s50
    v_cmp_eq_u32 vcc, 1, v3
    s_nop 1
    v_cndmask_b32 v4, v4, v5, vcc
    v_lshlrev_b32 v4, 3, v4
    v_add_u32 v4, v4, v2
    s_lshl_b32 s48, s26, 1
    v_add_u32 v4, s48, v4
    v_mul_u32_u24 v4, 64, v4
    v_add_u32 v21, 0x705000, v4
    s_lshl_b32 s59, s64, 10
    s_and_b32 s53, s65, 7
    s_lshl_b32 s53, s53, 10
    v_add_u32 v22, s62, v11
    v_add_u32 v23, s63, v11
    v_add_u32 v25, s68, v11
    v_add_u32 v26, s69, v11
    s_add_u32 m0, s58, 0
    s_add_u32 s48, s67, 65536
    buffer_load_dwordx4 v9, s[36:39], s67 offen lds
    s_add_u32 m0, s58, 1024
    s_cmp_eq_u32 s48, s61
    buffer_load_dwordx4 v27, s[36:39], s67 offen lds
    s_cselect_b32 s67, s66, s48
    s_add_u32 m0, s58, 2048
    s_add_u32 s48, s67, 65536
    buffer_load_dwordx4 v9, s[36:39], s67 offen lds
    s_add_u32 m0, s58, 3072
    s_cmp_eq_u32 s48, s61
    buffer_load_dwordx4 v27, s[36:39], s67 offen lds
    s_cselect_b32 s67, s66, s48
    s_add_u32 m0, s58, 4096
    s_add_u32 s48, s67, 65536
    buffer_load_dwordx4 v9, s[36:39], s67 offen lds
    s_add_u32 m0, s58, 5120
    s_cmp_eq_u32 s48, s61
    buffer_load_dwordx4 v27, s[36:39], s67 offen lds
    s_cselect_b32 s67, s66, s48
    s_add_u32 m0, s58, 6144
    s_add_u32 s48, s67, 65536
    buffer_load_dwordx4 v9, s[36:39], s67 offen lds
    s_add_u32 m0, s58, 7168
    s_cmp_eq_u32 s48, s61
    buffer_load_dwordx4 v27, s[36:39], s67 offen lds
    s_cselect_b32 s67, s66, s48
    s_add_u32 m0, s58, 8192
    s_add_u32 s48, s67, 65536
    buffer_load_dwordx4 v9, s[36:39], s67 offen lds
    s_add_u32 m0, s58, 9216
    s_cmp_eq_u32 s48, s61
    buffer_load_dwordx4 v27, s[36:39], s67 offen lds
    s_cselect_b32 s67, s66, s48
    s_add_u32 m0, s58, 10240
    s_add_u32 s48, s67, 65536
    buffer_load_dwordx4 v9, s[36:39], s67 offen lds
    s_add_u32 m0, s58, 11264
    s_cmp_eq_u32 s48, s61
    buffer_load_dwordx4 v27, s[36:39], s67 offen lds
    s_cselect_b32 s67, s66, s48
    s_waitcnt vmcnt(21)
    ds_read_b64_tr_b16 a[48:49], v18 offset:12288
    ds_read_b64_tr_b16 a[50:51], v18 offset:13312
    ds_read_b64_tr_b16 a[52:53], v19 offset:12288
    ds_read_b64_tr_b16 a[54:55], v19 offset:13312
    ds_read_b64_tr_b16 a[56:57], v18 offset:14336
    ds_read_b64_tr_b16 a[58:59], v18 offset:15360
    ds_read_b64_tr_b16 a[60:61], v19 offset:14336
    ds_read_b64_tr_b16 a[62:63], v19 offset:15360
    s_waitcnt lgkmcnt(4)
    ds_read_b64_tr_b16 a[64:65], v18 offset:16384
    ds_read_b64_tr_b16 a[66:67], v18 offset:17408
    ds_read_b64_tr_b16 a[68:69], v19 offset:16384
    ds_read_b64_tr_b16 a[70:71], v19 offset:17408
    ds_read_b64_tr_b16 a[72:73], v18 offset:18432
    ds_read_b64_tr_b16 a[74:75], v18 offset:19456
    ds_read_b64_tr_b16 a[76:77], v19 offset:18432
    ds_read_b64_tr_b16 a[78:79], v19 offset:19456
    s_waitcnt lgkmcnt(4)
    s_waitcnt lgkmcnt(0)
    s_add_u32 m0, s58, 12288
    s_add_u32 s48, s67, 65536
    buffer_load_dwordx4 v9, s[36:39], s67 offen lds
    s_add_u32 m0, s58, 13312
    s_cmp_eq_u32 s48, s61
    buffer_load_dwordx4 v27, s[36:39], s67 offen lds
    s_cselect_b32 s67, s66, s48
    s_add_u32 m0, s58, 14336
    s_add_u32 s48, s67, 65536
    buffer_load_dwordx4 v9, s[36:39], s67 offen lds
    s_add_u32 m0, s58, 15360
    s_cmp_eq_u32 s48, s61
    buffer_load_dwordx4 v27, s[36:39], s67 offen lds
    s_cselect_b32 s67, s66, s48
    s_add_u32 m0, s58, 16384
    s_add_u32 s48, s67, 65536
    buffer_load_dwordx4 v9, s[36:39], s67 offen lds
    s_add_u32 m0, s58, 17408
    s_cmp_eq_u32 s48, s61
    buffer_load_dwordx4 v27, s[36:39], s67 offen lds
    s_cselect_b32 s67, s66, s48
    s_add_u32 m0, s58, 18432
    s_add_u32 s48, s67, 65536
    buffer_load_dwordx4 v9, s[36:39], s67 offen lds
    s_add_u32 m0, s58, 19456
    s_cmp_eq_u32 s48, s61
    buffer_load_dwordx4 v27, s[36:39], s67 offen lds
    s_cselect_b32 s67, s66, s48
    s_waitcnt vmcnt(16)
    ds_read_b64_tr_b16 a[80:81], v18 offset:20480
    ds_read_b64_tr_b16 a[82:83], v18 offset:21504
    ds_read_b64_tr_b16 a[84:85], v19 offset:20480
    ds_read_b64_tr_b16 a[86:87], v19 offset:21504
    ds_read_b64_tr_b16 a[88:89], v18 offset:22528
    ds_read_b64_tr_b16 a[90:91], v18 offset:23552
    ds_read_b64_tr_b16 a[92:93], v19 offset:22528
    ds_read_b64_tr_b16 a[94:95], v19 offset:23552
    s_waitcnt lgkmcnt(4)
    ds_read_b64_tr_b16 a[96:97], v18 offset:0
    ds_read_b64_tr_b16 a[98:99], v18 offset:1024
    ds_read_b64_tr_b16 a[100:101], v19 offset:0
    ds_read_b64_tr_b16 a[102:103], v19 offset:1024
    ds_read_b64_tr_b16 a[104:105], v18 offset:2048
    ds_read_b64_tr_b16 a[106:107], v18 offset:3072
    ds_read_b64_tr_b16 a[108:109], v19 offset:2048
    ds_read_b64_tr_b16 a[110:111], v19 offset:3072
    s_waitcnt lgkmcnt(4)
    s_waitcnt lgkmcnt(0)
    s_add_u32 s48, s65, 0
    s_and_b32 s48, s48, 7
    s_lshl_b32 s48, s48, 14
    s_add_u32 m0, s58, 20480
    s_add_u32 s48, s48, s60
    buffer_load_dwordx4 v10, s[32:35], s48 offen lds
    s_add_u32 m0, s58, 21504
    s_add_u32 s48, s48, 8192
    buffer_load_dwordx4 v10, s[32:35], s48 offen lds
    s_add_u32 s48, s65, 1
    s_and_b32 s48, s48, 7
    s_lshl_b32 s48, s48, 14
    s_add_u32 m0, s58, 22528
    s_add_u32 s48, s48, s60
    buffer_load_dwordx4 v10, s[32:35], s48 offen lds
    s_add_u32 m0, s58, 23552
    s_add_u32 s48, s48, 8192
    buffer_load_dwordx4 v10, s[32:35], s48 offen lds
    s_add_u32 s48, s65, 2
    s_and_b32 s48, s48, 7
    s_lshl_b32 s48, s48, 14
    s_add_u32 m0, s58, 0
    s_add_u32 s48, s48, s60
    buffer_load_dwordx4 v10, s[32:35], s48 offen lds
    s_add_u32 m0, s58, 1024
    s_add_u32 s48, s48, 8192
    buffer_load_dwordx4 v10, s[32:35], s48 offen lds
    s_add_u32 s48, s65, 3
    s_and_b32 s48, s48, 7
    s_lshl_b32 s48, s48, 14
    s_add_u32 m0, s58, 2048
    s_add_u32 s48, s48, s60
    buffer_load_dwordx4 v10, s[32:35], s48 offen lds
    s_add_u32 m0, s58, 3072
    s_add_u32 s48, s48, 8192
    buffer_load_dwordx4 v10, s[32:35], s48 offen lds
    s_waitcnt vmcnt(20)
    ds_read_b64_tr_b16 a[112:113], v18 offset:4096
    ds_read_b64_tr_b16 a[114:115], v18 offset:5120
    ds_read_b64_tr_b16 a[116:117], v19 offset:4096
    ds_read_b64_tr_b16 a[118:119], v19 offset:5120
    ds_read_b64_tr_b16 a[120:121], v18 offset:6144
    ds_read_b64_tr_b16 a[122:123], v18 offset:7168
    ds_read_b64_tr_b16 a[124:125], v19 offset:6144
    ds_read_b64_tr_b16 a[126:127], v19 offset:7168
    s_waitcnt lgkmcnt(4)
    s_waitcnt lgkmcnt(0)
    s_add_u32 s48, s65, 4
    s_and_b32 s48, s48, 7
    s_lshl_b32 s48, s48, 14
    s_add_u32 m0, s58, 4096
    s_add_u32 s48, s48, s60
    buffer_load_dwordx4 v10, s[32:35], s48 offen lds
    s_add_u32 m0, s58, 5120
    s_add_u32 s48, s48, 8192
    buffer_load_dwordx4 v10, s[32:35], s48 offen lds
    s_add_u32 s48, s65, 5
    s_and_b32 s48, s48, 7
    s_lshl_b32 s48, s48, 14
    s_add_u32 m0, s58, 6144
    s_add_u32 s48, s48, s60
    buffer_load_dwordx4 v10, s[32:35], s48 offen lds
    s_add_u32 m0, s58, 7168
    s_add_u32 s48, s48, 8192
    buffer_load_dwordx4 v10, s[32:35], s48 offen lds
    buffer_load_dwordx2 v[30:31], v20, s[28:31], 0 offen sc1
    s_waitcnt vmcnt(17)
    ds_read_b64_tr_b16 a[128:129], v18 offset:8192
    ds_read_b64_tr_b16 a[130:131], v18 offset:9216
    ds_read_b64_tr_b16 a[132:133], v19 offset:8192
    ds_read_b64_tr_b16 a[134:135], v19 offset:9216
    ds_read_b64_tr_b16 a[136:137], v18 offset:10240
    ds_read_b64_tr_b16 a[138:139], v18 offset:11264
    ds_read_b64_tr_b16 a[140:141], v19 offset:10240
    ds_read_b64_tr_b16 a[142:143], v19 offset:11264
    s_waitcnt lgkmcnt(4)
    ds_read_b64_tr_b16 a[144:145], v18 offset:12288
    ds_read_b64_tr_b16 a[146:147], v18 offset:13312
    ds_read_b64_tr_b16 a[148:149], v19 offset:12288
    ds_read_b64_tr_b16 a[150:151], v19 offset:13312
    ds_read_b64_tr_b16 a[152:153], v18 offset:14336
    ds_read_b64_tr_b16 a[154:155], v18 offset:15360
    ds_read_b64_tr_b16 a[156:157], v19 offset:14336
    ds_read_b64_tr_b16 a[158:159], v19 offset:15360
    s_waitcnt lgkmcnt(4)
    s_waitcnt lgkmcnt(0)
    s_add_u32 s48, s65, 6
    s_and_b32 s48, s48, 7
    s_lshl_b32 s48, s48, 14
    s_add_u32 m0, s58, 8192
    s_add_u32 s48, s48, s60
    buffer_load_dwordx4 v10, s[32:35], s48 offen lds
    s_add_u32 m0, s58, 9216
    s_add_u32 s48, s48, 8192
    buffer_load_dwordx4 v10, s[32:35], s48 offen lds
    s_add_u32 s48, s65, 7
    s_and_b32 s48, s48, 7
    s_lshl_b32 s48, s48, 14
    s_add_u32 m0, s58, 10240
    s_add_u32 s48, s48, s60
    buffer_load_dwordx4 v10, s[32:35], s48 offen lds
    s_add_u32 m0, s58, 11264
    s_add_u32 s48, s48, 8192
    buffer_load_dwordx4 v10, s[32:35], s48 offen lds
    s_branch L_final
L_qrole:
    s_and_b32 s77, s49, 7
    s_sub_u32 s51, s48, 6
    s_lshl_b32 s51, s51, 2
    s_lshr_b32 s76, s49, 3
    s_add_u32 s76, s76, s51
    s_add_u32 s51, s48, 4
    s_cmp_lt_u32 s48, 6
    s_cselect_b32 s76, s51, s76
    s_mov_b32 s32, s4
    s_and_b32 s33, s5, 0xffff
    s_mov_b32 s34, 0x200000
    s_mov_b32 s35, 0x20000
    s_mov_b32 s36, s6
    s_and_b32 s37, s7, 0xffff
    s_mov_b32 s38, 0x180000
    s_mov_b32 s39, 0x20000
    s_and_b32 s56, s26, 1
    s_lshl_b32 s56, s56, 2
    v_lshrrev_b32 v2, 3, v1
    v_and_b32 v3, 7, v1
    v_lshrrev_b32 v4, 4, v1
    v_xor_b32 v4, v3, v4
    v_xor_b32 v4, s56, v4
    v_lshlrev_b32 v5, 10, v2
    v_lshl_add_u32 v10, v4, 4, v5
    v_bfe_u32 v4, v1, 4, 1
    v_lshlrev_b32 v4, 1, v4
    v_xor_b32 v4, v3, v4
    v_xor_b32 v4, s56, v4
    v_mul_u32_u24 v5, 3072, v2
    v_lshl_add_u32 v11, v4, 4, v5
    s_mul_i32 s58, s76, 208
    s_lshl_b32 s48, s26, 3
    s_add_u32 s59, s58, s48
    s_sub_i32 s59, s59, 16
    s_max_i32 s60, s59, 0
    s_lshl_b32 s60, s60, 10
    s_add_u32 s59, s59, 32
    s_lshl_b32 s59, s59, 10
    s_mul_i32 s61, s26, 24576
    s_lshl_b32 s48, s77, 7
    s_add_u32 s61, s61, s48
    s_lshl_b32 s62, s26, 10
    s_and_b32 s63, s76, 3
    s_lshl_b32 s63, s63, 1
    s_add_u32 s63, s63, s77
    s_and_b32 s48, s2, 1
    s_add_u32 s63, s63, s48
    s_add_u32 s48, s63, 0
    s_and_b32 s48, s48, 7
    s_lshl_b32 s64, s48, 7
    s_mul_i32 s65, s48, 196608
    s_add_u32 s65, s65, s61
    s_add_u32 s66, s64, s60
    s_add_u32 s64, s64, s59
    s_add_u32 m0, s62, 0
    s_mov_b32 s48, s66
    buffer_load_dwordx4 v10, s[32:35], s48 offen lds
    s_add_u32 m0, s62, 4096
    s_add_u32 s48, s64, 0
    buffer_load_dwordx4 v10, s[32:35], s48 offen lds
    s_add_u32 m0, s62, 8192
    s_add_u32 s48, s64, 32768
    buffer_load_dwordx4 v10, s[32:35], s48 offen lds
    s_add_u32 m0, s62, 12288
    s_add_u32 s48, s64, 65536
    buffer_load_dwordx4 v10, s[32:35], s48 offen lds
    s_add_u32 m0, s62, 16384
    s_add_u32 s48, s64, 98304
    buffer_load_dwordx4 v10, s[32:35], s48 offen lds
    s_add_u32 m0, s62, 20480
    s_add_u32 s48, s64, 131072
    buffer_load_dwordx4 v10, s[32:35], s48 offen lds
    s_add_u32 m0, s62, 24576
    s_add_u32 s48, s64, 163840
    buffer_load_dwordx4 v10, s[32:35], s48 offen lds
    s_add_u32 m0, s62, 28672
    s_add_u32 s48, s65, 0
    buffer_load_dwordx4 v11, s[36:39], s48 offen lds
    s_add_u32 m0, s62, 32768
    s_add_u32 s48, s65, 98304
    buffer_load_dwordx4 v11, s[36:39], s48 offen lds
    s_add_u32 m0, s62, 36864
    s_add_u32 s48, s65, 1024
    buffer_load_dwordx4 v11, s[36:39], s48 offen lds
    s_add_u32 m0, s62, 40960
    s_add_u32 s48, s65, 99328
    buffer_load_dwordx4 v11, s[36:39], s48 offen lds
    s_add_u32 m0, s62, 45056
    s_add_u32 s48, s65, 2048
    buffer_load_dwordx4 v11, s[36:39], s48 offen lds
    s_add_u32 m0, s62, 49152
    s_add_u32 s48, s65, 100352
    buffer_load_dwordx4 v11, s[36:39], s48 offen lds
    v_and_b32 v2, 15, v1
    v_lshrrev_b32 v3, 4, v1
    v_lshrrev_b32 v4, 1, v2
    v_xor_b32 v4, v3, v4
    v_lshlrev_b32 v5, 7, v2
    v_lshl_add_u32 v5, v4, 4, v5
    v_add_u32 v12, 0, v5
    v_xor_b32 v13, 64, v12
    v_add_u32 v14, 53248, v5
    v_xor_b32 v15, 64, v14
    v_add_u32 v16, 106496, v5
    v_xor_b32 v17, 64, v16
    v_bfe_u32 v4, v1, 2, 2
    v_lshl_add_u32 v5, v3, 3, v4
    v_lshlrev_b32 v5, 7, v5
    v_lshrrev_b32 v6, 1, v4
    v_and_b32 v7, 1, v3
    v_lshl_add_u32 v6, v7, 1, v6
    v_lshlrev_b32 v6, 1, v6
    v_bfe_u32 v7, v1, 1, 1
    s_lshl_b32 s57, s26, 1
    v_add_u32 v7, s57, v7
    v_xor_b32 v6, v6, v7
    v_lshl_add_u32 v5, v6, 4, v5
    v_and_b32 v7, 1, v1
    v_lshl_add_u32 v5, v7, 3, v5
    v_add_u32 v18, 28672, v5
    v_add_u32 v19, 81920, v5
    v_add_u32 v20, 135168, v5
    v_mov_b32 v28, 0x3f803f80
    v_mov_b32 v29, 0x3f803f80
    v_mov_b32 v30, 0x3f803f80
    v_mov_b32 v31, 0x3f803f80
    s_mul_i32 s48, s76, 13
    s_sub_i32 s49, s48, 1
    s_add_u32 s50, s48, 12
    s_min_u32 s50, s50, 127
    v_add_u32 v32, s49, v1
    v_max_i32 v32, 0, v32
    v_min_i32 v32, s50, v32
    v_mul_u32_u24 v32, 64, v32
    v_add_u32 v32, 0x700000, v32
    s_lshl_b32 s48, s26, 6
    s_add_u32 s48, s48, s58
    s_sub_i32 s48, s48, 16
    v_add_u32 v33, s48, v1
    v_max_i32 v33, 0, v33
    v_min_i32 v33, 0x7ff, v33
    v_lshlrev_b32 v33, 2, v33
    v_mov_b32 v34, 0
    s_waitcnt vmcnt(0)
    s_barrier
    ds_read_b64_tr_b16 a[112:113], v18 offset:0
    ds_read_b64_tr_b16 a[114:115], v18 offset:512
    ds_read_b64_tr_b16 a[116:117], v18 offset:8192
    ds_read_b64_tr_b16 a[118:119], v18 offset:8704
    ds_read_b64_tr_b16 a[120:121], v18 offset:16384
    ds_read_b64_tr_b16 a[122:123], v18 offset:16896
    ds_read_b128 a[0:3], v12 offset:0
    ds_read_b128 a[4:7], v12 offset:2048
    ds_read_b128 a[8:11], v12 offset:4096
    ds_read_b128 a[12:15], v12 offset:6144
    ds_read_b128 a[16:19], v12 offset:8192
    ds_read_b128 a[20:23], v12 offset:10240
    ds_read_b128 a[24:27], v12 offset:12288
    ds_read_b128 a[28:31], v12 offset:14336
    s_waitcnt lgkmcnt(10)
    ds_read_b128 a[32:35], v12 offset:16384
    ds_read_b128 a[36:39], v12 offset:18432
    ds_read_b128 a[40:43], v12 offset:20480
    ds_read_b128 a[44:47], v12 offset:22528
    s_waitcnt lgkmcnt(10)
    ds_read_b128 a[48:51], v12 offset:24576
    ds_read_b128 a[52:55], v12 offset:26624
    v_mfma_f32_16x16x32_bf16 v[72:75], a[112:115], v[28:31], 0
    s_add_u32 s48, s63, 1
    s_and_b32 s48, s48, 7
    s_lshl_b32 s64, s48, 7
    s_mul_i32 s65, s48, 196608
    s_add_u32 s65, s65, s61
    s_add_u32 s66, s64, s60
    s_add_u32 s64, s64, s59
    s_add_u32 m0, s62, 53248
    s_mov_b32 s48, s66
    buffer_load_dwordx4 v10, s[32:35], s48 offen lds
    v_mfma_f32_16x16x32_bf16 v[76:79], a[116:119], v[28:31], 0
    ds_read_b64_tr_b16 a[124:125], v18 offset:4096
    s_add_u32 m0, s62, 57344
    s_add_u32 s48, s64, 0
    buffer_load_dwordx4 v10, s[32:35], s48 offen lds
    v_mfma_f32_16x16x32_bf16 v[80:83], v[28:31], a[120:123], 0
    v_mfma_f32_16x16x32_bf16 v[136:139], a[116:119], a[0:3], 0
    ds_read_b64_tr_b16 a[126:127], v18 offset:4608
    s_waitcnt lgkmcnt(10)
    s_add_u32 m0, s62, 61440
    s_add_u32 s48, s64, 32768
    buffer_load_dwordx4 v10, s[32:35], s48 offen lds
    v_mfma_f32_16x16x32_bf16 v[192:195], a[0:3], a[120:123], 0
    ds_read_b64_tr_b16 a[128:129], v18 offset:12288
    v_mfma_f32_16x16x32_bf16 v[84:87], a[112:115], a[4:7], 0
    s_add_u32 m0, s62, 65536
    s_add_u32 s48, s64, 65536
    buffer_load_dwordx4 v10, s[32:35], s48 offen lds
    v_mfma_f32_16x16x32_bf16 v[140:143], a[116:119], a[4:7], 0
    ds_read_b64_tr_b16 a[130:131], v18 offset:12800
    s_add_u32 m0, s62, 69632
    s_add_u32 s48, s64, 98304
    buffer_load_dwordx4 v10, s[32:35], s48 offen lds
    v_mfma_f32_16x16x32_bf16 v[196:199], a[4:7], a[120:123], 0
    ds_read_b64_tr_b16 a[132:133], v18 offset:20480
    v_mfma_f32_16x16x32_bf16 v[88:91], a[112:115], a[8:11], 0
    s_add_u32 m0, s62, 73728
    s_add_u32 s48, s64, 131072
    buffer_load_dwordx4 v10, s[32:35], s48 offen lds
    v_mfma_f32_16x16x32_bf16 v[144:147], a[116:119], a[8:11], 0
    ds_read_b64_tr_b16 a[134:135], v18 offset:20992
    s_waitcnt lgkmcnt(10)
    v_mfma_f32_16x16x32_bf16 v[200:203], a[8:11], a[120:123], 0
    ds_read_b128 a[56:59], v13 offset:0
    s_add_u32 m0, s62, 77824
    s_add_u32 s48, s64, 163840
    buffer_load_dwordx4 v10, s[32:35], s48 offen lds
    v_mfma_f32_16x16x32_bf16 v[92:95], a[112:115], a[12:15], 0
    s_add_u32 m0, s62, 81920
    s_add_u32 s48, s65, 0
    buffer_load_dwordx4 v11, s[36:39], s48 offen lds
    v_mfma_f32_16x16x32_bf16 v[148:151], a[116:119], a[12:15], 0
    ds_read_b128 a[60:63], v13 offset:2048
    v_mfma_f32_16x16x32_bf16 v[204:207], a[12:15], a[120:123], 0
    ds_read_b128 a[64:67], v13 offset:4096
    s_add_u32 m0, s62, 86016
    s_add_u32 s48, s65, 98304
    buffer_load_dwordx4 v11, s[36:39], s48 offen lds
    v_mfma_f32_16x16x32_bf16 v[96:99], a[112:115], a[16:19], 0
    v_mfma_f32_16x16x32_bf16 v[152:155], a[116:119], a[16:19], 0
    ds_read_b128 a[68:71], v13 offset:6144
    s_waitcnt lgkmcnt(10)
    s_add_u32 m0, s62, 90112
    s_add_u32 s48, s65, 1024
    buffer_load_dwordx4 v11, s[36:39], s48 offen lds
    v_mfma_f32_16x16x32_bf16 v[208:211], a[16:19], a[120:123], 0
    ds_read_b128 a[72:75], v13 offset:8192
    s_add_u32 m0, s62, 94208
    s_add_u32 s48, s65, 99328
    buffer_load_dwordx4 v11, s[36:39], s48 offen lds
    v_mfma_f32_16x16x32_bf16 v[100:103], a[112:115], a[20:23], 0
    v_mfma_f32_16x16x32_bf16 v[156:159], a[116:119], a[20:23], 0
    ds_read_b128 a[76:79], v13 offset:10240
    s_add_u32 m0, s62, 98304
    s_add_u32 s48, s65, 2048
    buffer_load_dwordx4 v11, s[36:39], s48 offen lds
    v_mfma_f32_16x16x32_bf16 v[212:215], a[20:23], a[120:123], 0
    v_mfma_f32_16x16x32_bf16 v[104:107], a[112:115], a[24:27], 0
    ds_read_b128 a[80:83], v13 offset:12288
    s_add_u32 m0, s62, 102400
    s_add_u32 s48, s65, 100352
    buffer_load_dwordx4 v11, s[36:39], s48 offen lds
    v_mfma_f32_16x16x32_bf16 v[160:163], a[116:119], a[24:27], 0
    ds_read_b128 a[84:87], v13 offset:14336
    s_waitcnt lgkmcnt(10)
    s_add_u32 s48, s63, 2
    s_and_b32 s48, s48, 7
    s_lshl_b32 s64, s48, 7
    s_mul_i32 s65, s48, 196608
    s_add_u32 s65, s65, s61
    s_add_u32 s66, s64, s60
    s_add_u32 s64, s64, s59
    s_add_u32 m0, s62, 106496
    s_mov_b32 s48, s66
    buffer_load_dwordx4 v10, s[32:35], s48 offen lds
    v_mfma_f32_16x16x32_bf16 v[216:219], a[24:27], a[120:123], 0
    v_mfma_f32_16x16x32_bf16 v[108:111], a[112:115], a[28:31], 0
    ds_read_b128 a[88:91], v13 offset:16384
    s_add_u32 m0, s62, 110592
    s_add_u32 s48, s64, 0
    buffer_load_dwordx4 v10, s[32:35], s48 offen lds
    v_mfma_f32_16x16x32_bf16 v[164:167], a[116:119], a[28:31], 0
    ds_read_b128 a[92:95], v13 offset:18432
    v_mfma_f32_16x16x32_bf16 v[220:223], a[28:31], a[120:123], 0
    s_add_u32 m0, s62, 114688
    s_add_u32 s48, s64, 32768
    buffer_load_dwordx4 v10, s[32:35], s48 offen lds
    v_mfma_f32_16x16x32_bf16 v[112:115], a[112:115], a[32:35], 0
    ds_read_b128 a[96:99], v13 offset:20480
    v_mfma_f32_16x16x32_bf16 v[168:171], a[116:119], a[32:35], 0
    ds_read_b128 a[100:103], v13 offset:22528
    s_waitcnt lgkmcnt(10)
    s_add_u32 m0, s62, 118784
    s_add_u32 s48, s64, 65536
    buffer_load_dwordx4 v10, s[32:35], s48 offen lds
    v_mfma_f32_16x16x32_bf16 v[224:227], a[32:35], a[120:123], 0
    s_add_u32 m0, s62, 122880
    s_add_u32 s48, s64, 98304
    buffer_load_dwordx4 v10, s[32:35], s48 offen lds
    v_mfma_f32_16x16x32_bf16 v[116:119], a[112:115], a[36:39], 0
    ds_read_b128 a[104:107], v13 offset:24576
    v_mfma_f32_16x16x32_bf16 v[172:175], a[116:119], a[36:39], 0
    ds_read_b128 a[108:111], v13 offset:26624
    s_add_u32 m0, s62, 126976
    s_add_u32 s48, s64, 131072
    buffer_load_dwordx4 v10, s[32:35], s48 offen lds
    v_mfma_f32_16x16x32_bf16 v[228:231], a[36:39], a[120:123], 0
    v_mfma_f32_16x16x32_bf16 v[120:123], a[112:115], a[40:43], 0
    s_add_u32 m0, s62, 131072
    s_add_u32 s48, s64, 163840
    buffer_load_dwordx4 v10, s[32:35], s48 offen lds
    v_mfma_f32_16x16x32_bf16 v[176:179], a[116:119], a[40:43], 0
    s_add_u32 m0, s62, 135168
    s_add_u32 s48, s65, 0
    buffer_load_dwordx4 v11, s[36:39], s48 offen lds
    v_mfma_f32_16x16x32_bf16 v[232:235], a[40:43], a[120:123], 0
    v_mfma_f32_16x16x32_bf16 v[124:127], a[112:115], a[44:47], 0
    s_add_u32 m0, s62, 139264
    s_add_u32 s48, s65, 98304
    buffer_load_dwordx4 v11, s[36:39], s48 offen lds
    v_mfma_f32_16x16x32_bf16 v[180:183], a[116:119], a[44:47], 0
    v_mfma_f32_16x16x32_bf16 v[236:239], a[44:47], a[120:123], 0
    s_add_u32 m0, s62, 143360
    s_add_u32 s48, s65, 1024
    buffer_load_dwordx4 v11, s[36:39], s48 offen lds
    v_mfma_f32_16x16x32_bf16 v[128:131], a[112:115], a[48:51], 0
    s_add_u32 m0, s62, 147456
    s_add_u32 s48, s65, 99328
    buffer_load_dwordx4 v11, s[36:39], s48 offen lds
    v_mfma_f32_16x16x32_bf16 v[184:187], a[116:119], a[48:51], 0
    v_mfma_f32_16x16x32_bf16 v[240:243], a[48:51], a[120:123], 0
    s_add_u32 m0, s62, 151552
    s_add_u32 s48, s65, 2048
    buffer_load_dwordx4 v11, s[36:39], s48 offen lds
    v_mfma_f32_16x16x32_bf16 v[132:135], a[112:115], a[52:55], 0
    v_mfma_f32_16x16x32_bf16 v[188:191], a[116:119], a[52:55], 0
    s_add_u32 m0, s62, 155648
    s_add_u32 s48, s65, 100352
    buffer_load_dwordx4 v11, s[36:39], s48 offen lds
    v_mfma_f32_16x16x32_bf16 v[244:247], a[52:55], a[120:123], 0
    s_waitcnt lgkmcnt(0)
    s_waitcnt vmcnt(13)
    s_barrier
    v_mfma_f32_16x16x32_bf16 v[72:75], a[124:127], v[28:31], v[72:75]
    s_add_u32 s48, s63, 3
    s_and_b32 s48, s48, 7
    s_lshl_b32 s64, s48, 7
    s_mul_i32 s65, s48, 196608
    s_add_u32 s65, s65, s61
    s_add_u32 s66, s64, s60
    s_add_u32 s64, s64, s59
    s_add_u32 m0, s62, 0
    s_mov_b32 s48, s66
    buffer_load_dwordx4 v10, s[32:35], s48 offen lds
    v_mfma_f32_16x16x32_bf16 v[76:79], a[128:131], v[28:31], v[76:79]
    ds_read_b64_tr_b16 a[112:113], v19 offset:0
    v_mfma_f32_16x16x32_bf16 v[80:83], v[28:31], a[132:135], v[80:83]
    v_mfma_f32_16x16x32_bf16 v[136:139], a[128:131], a[56:59], v[136:139]
    ds_read_b64_tr_b16 a[114:115], v19 offset:512
    v_mfma_f32_16x16x32_bf16 v[192:195], a[56:59], a[132:135], v[192:195]
    ds_read_b64_tr_b16 a[116:117], v19 offset:8192
    v_mfma_f32_16x16x32_bf16 v[84:87], a[124:127], a[60:63], v[84:87]
    v_mfma_f32_16x16x32_bf16 v[140:143], a[128:131], a[60:63], v[140:143]
    ds_read_b64_tr_b16 a[118:119], v19 offset:8704
    s_add_u32 m0, s62, 4096
    s_add_u32 s48, s64, 0
    buffer_load_dwordx4 v10, s[32:35], s48 offen lds
    v_mfma_f32_16x16x32_bf16 v[196:199], a[60:63], a[132:135], v[196:199]
    ds_read_b64_tr_b16 a[120:121], v19 offset:16384
    v_mfma_f32_16x16x32_bf16 v[88:91], a[124:127], a[64:67], v[88:91]
    v_mfma_f32_16x16x32_bf16 v[144:147], a[128:131], a[64:67], v[144:147]
    ds_read_b64_tr_b16 a[122:123], v19 offset:16896
    v_mfma_f32_16x16x32_bf16 v[200:203], a[64:67], a[132:135], v[200:203]
    ds_read_b128 a[0:3], v14 offset:0
    v_mfma_f32_16x16x32_bf16 v[92:95], a[124:127], a[68:71], v[92:95]
    v_mfma_f32_16x16x32_bf16 v[148:151], a[128:131], a[68:71], v[148:151]
    ds_read_b128 a[4:7], v14 offset:2048
    s_add_u32 m0, s62, 8192
    s_add_u32 s48, s64, 32768
    buffer_load_dwordx4 v10, s[32:35], s48 offen lds
    v_mfma_f32_16x16x32_bf16 v[204:207], a[68:71], a[132:135], v[204:207]
    ds_read_b128 a[8:11], v14 offset:4096
    v_mfma_f32_16x16x32_bf16 v[96:99], a[124:127], a[72:75], v[96:99]
    v_mfma_f32_16x16x32_bf16 v[152:155], a[128:131], a[72:75], v[152:155]
    ds_read_b128 a[12:15], v14 offset:6144
    v_mfma_f32_16x16x32_bf16 v[208:211], a[72:75], a[132:135], v[208:211]
    ds_read_b128 a[16:19], v14 offset:8192
    v_mfma_f32_16x16x32_bf16 v[100:103], a[124:127], a[76:79], v[100:103]
    v_mfma_f32_16x16x32_bf16 v[156:159], a[128:131], a[76:79], v[156:159]
    ds_read_b128 a[20:23], v14 offset:10240
    s_add_u32 m0, s62, 12288
    s_add_u32 s48, s64, 65536
    buffer_load_dwordx4 v10, s[32:35], s48 offen lds
    v_mfma_f32_16x16x32_bf16 v[212:215], a[76:79], a[132:135], v[212:215]
    v_mfma_f32_16x16x32_bf16 v[104:107], a[124:127], a[80:83], v[104:107]
    ds_read_b128 a[24:27], v14 offset:12288
    v_mfma_f32_16x16x32_bf16 v[160:163], a[128:131], a[80:83], v[160:163]
    ds_read_b128 a[28:31], v14 offset:14336
    s_waitcnt lgkmcnt(10)
    v_mfma_f32_16x16x32_bf16 v[216:219], a[80:83], a[132:135], v[216:219]
    v_mfma_f32_16x16x32_bf16 v[108:111], a[124:127], a[84:87], v[108:111]
    ds_read_b128 a[32:35], v14 offset:16384
    v_mfma_f32_16x16x32_bf16 v[164:167], a[128:131], a[84:87], v[164:167]
    ds_read_b128 a[36:39], v14 offset:18432
    v_mfma_f32_16x16x32_bf16 v[220:223], a[84:87], a[132:135], v[220:223]
    s_add_u32 m0, s62, 16384
    s_add_u32 s48, s64, 98304
    buffer_load_dwordx4 v10, s[32:35], s48 offen lds
    v_mfma_f32_16x16x32_bf16 v[112:115], a[124:127], a[88:91], v[112:115]
    ds_read_b128 a[40:43], v14 offset:20480
    v_mfma_f32_16x16x32_bf16 v[168:171], a[128:131], a[88:91], v[168:171]
    ds_read_b128 a[44:47], v14 offset:22528
    s_waitcnt lgkmcnt(10)
    v_mfma_f32_16x16x32_bf16 v[224:227], a[88:91], a[132:135], v[224:227]
    v_mfma_f32_16x16x32_bf16 v[116:119], a[124:127], a[92:95], v[116:119]
    ds_read_b128 a[48:51], v14 offset:24576
    v_mfma_f32_16x16x32_bf16 v[172:175], a[128:131], a[92:95], v[172:175]
    ds_read_b128 a[52:55], v14 offset:26624
    v_mfma_f32_16x16x32_bf16 v[228:231], a[92:95], a[132:135], v[228:231]
    s_add_u32 m0, s62, 20480
    s_add_u32 s48, s64, 131072
    buffer_load_dwordx4 v10, s[32:35], s48 offen lds
    v_mfma_f32_16x16x32_bf16 v[120:123], a[124:127], a[96:99], v[120:123]
    v_mfma_f32_16x16x32_bf16 v[176:179], a[128:131], a[96:99], v[176:179]
    v_mfma_f32_16x16x32_bf16 v[232:235], a[96:99], a[132:135], v[232:235]
    v_mfma_f32_16x16x32_bf16 v[124:127], a[124:127], a[100:103], v[124:127]
    v_mfma_f32_16x16x32_bf16 v[180:183], a[128:131], a[100:103], v[180:183]
    v_mfma_f32_16x16x32_bf16 v[236:239], a[100:103], a[132:135], v[236:239]
    s_add_u32 m0, s62, 24576
    s_add_u32 s48, s64, 163840
    buffer_load_dwordx4 v10, s[32:35], s48 offen lds
    v_mfma_f32_16x16x32_bf16 v[128:131], a[124:127], a[104:107], v[128:131]
    v_mfma_f32_16x16x32_bf16 v[184:187], a[128:131], a[104:107], v[184:187]
    v_mfma_f32_16x16x32_bf16 v[240:243], a[104:107], a[132:135], v[240:243]
    v_mfma_f32_16x16x32_bf16 v[132:135], a[124:127], a[108:111], v[132:135]
    v_mfma_f32_16x16x32_bf16 v[188:191], a[128:131], a[108:111], v[188:191]
    v_mfma_f32_16x16x32_bf16 v[244:247], a[108:111], a[132:135], v[244:247]
    v_mfma_f32_16x16x32_bf16 v[72:75], a[112:115], v[28:31], v[72:75]
    s_add_u32 m0, s62, 28672
    s_add_u32 s48, s65, 0
    buffer_load_dwordx4 v11, s[36:39], s48 offen lds
    v_mfma_f32_16x16x32_bf16 v[76:79], a[116:119], v[28:31], v[76:79]
    ds_read_b64_tr_b16 a[124:125], v19 offset:4096
    v_mfma_f32_16x16x32_bf16 v[80:83], v[28:31], a[120:123], v[80:83]
    v_mfma_f32_16x16x32_bf16 v[136:139], a[116:119], a[0:3], v[136:139]
    ds_read_b64_tr_b16 a[126:127], v19 offset:4608
    s_waitcnt lgkmcnt(10)
    v_mfma_f32_16x16x32_bf16 v[192:195], a[0:3], a[120:123], v[192:195]
    ds_read_b64_tr_b16 a[128:129], v19 offset:12288
    v_mfma_f32_16x16x32_bf16 v[84:87], a[112:115], a[4:7], v[84:87]
    v_mfma_f32_16x16x32_bf16 v[140:143], a[116:119], a[4:7], v[140:143]
    ds_read_b64_tr_b16 a[130:131], v19 offset:12800
    v_mfma_f32_16x16x32_bf16 v[196:199], a[4:7], a[120:123], v[196:199]
    ds_read_b64_tr_b16 a[132:133], v19 offset:20480
    s_add_u32 m0, s62, 32768
    s_add_u32 s48, s65, 98304
    buffer_load_dwordx4 v11, s[36:39], s48 offen lds
    v_mfma_f32_16x16x32_bf16 v[88:91], a[112:115], a[8:11], v[88:91]
    v_mfma_f32_16x16x32_bf16 v[144:147], a[116:119], a[8:11], v[144:147]
    ds_read_b64_tr_b16 a[134:135], v19 offset:20992
    s_waitcnt lgkmcnt(10)
    v_mfma_f32_16x16x32_bf16 v[200:203], a[8:11], a[120:123], v[200:203]
    ds_read_b128 a[56:59], v15 offset:0
    v_mfma_f32_16x16x32_bf16 v[92:95], a[112:115], a[12:15], v[92:95]
    v_mfma_f32_16x16x32_bf16 v[148:151], a[116:119], a[12:15], v[148:151]
    ds_read_b128 a[60:63], v15 offset:2048
    v_mfma_f32_16x16x32_bf16 v[204:207], a[12:15], a[120:123], v[204:207]
    ds_read_b128 a[64:67], v15 offset:4096
    v_mfma_f32_16x16x32_bf16 v[96:99], a[112:115], a[16:19], v[96:99]
    s_add_u32 m0, s62, 36864
    s_add_u32 s48, s65, 1024
    buffer_load_dwordx4 v11, s[36:39], s48 offen lds
    v_mfma_f32_16x16x32_bf16 v[152:155], a[116:119], a[16:19], v[152:155]
    ds_read_b128 a[68:71], v15 offset:6144
    s_waitcnt lgkmcnt(10)
    v_mfma_f32_16x16x32_bf16 v[208:211], a[16:19], a[120:123], v[208:211]
    ds_read_b128 a[72:75], v15 offset:8192
    v_mfma_f32_16x16x32_bf16 v[100:103], a[112:115], a[20:23], v[100:103]
    v_mfma_f32_16x16x32_bf16 v[156:159], a[116:119], a[20:23], v[156:159]
    ds_read_b128 a[76:79], v15 offset:10240
    v_mfma_f32_16x16x32_bf16 v[212:215], a[20:23], a[120:123], v[212:215]
    v_mfma_f32_16x16x32_bf16 v[104:107], a[112:115], a[24:27], v[104:107]
    ds_read_b128 a[80:83], v15 offset:12288
    v_mfma_f32_16x16x32_bf16 v[160:163], a[116:119], a[24:27], v[160:163]
    ds_read_b128 a[84:87], v15 offset:14336
    s_waitcnt lgkmcnt(10)
    s_add_u32 m0, s62, 40960
    s_add_u32 s48, s65, 99328
    buffer_load_dwordx4 v11, s[36:39], s48 offen lds
    v_mfma_f32_16x16x32_bf16 v[216:219], a[24:27], a[120:123], v[216:219]
    v_mfma_f32_16x16x32_bf16 v[108:111], a[112:115], a[28:31], v[108:111]
    ds_read_b128 a[88:91], v15 offset:16384
    v_mfma_f32_16x16x32_bf16 v[164:167], a[116:119], a[28:31], v[164:167]
    ds_read_b128 a[92:95], v15 offset:18432
    v_mfma_f32_16x16x32_bf16 v[220:223], a[28:31], a[120:123], v[220:223]
    v_mfma_f32_16x16x32_bf16 v[112:115], a[112:115], a[32:35], v[112:115]
    ds_read_b128 a[96:99], v15 offset:20480
    v_mfma_f32_16x16x32_bf16 v[168:171], a[116:119], a[32:35], v[168:171]
    ds_read_b128 a[100:103], v15 offset:22528
    s_waitcnt lgkmcnt(10)
    v_mfma_f32_16x16x32_bf16 v[224:227], a[32:35], a[120:123], v[224:227]
    v_mfma_f32_16x16x32_bf16 v[116:119], a[112:115], a[36:39], v[116:119]
    ds_read_b128 a[104:107], v15 offset:24576
    s_add_u32 m0, s62, 45056
    s_add_u32 s48, s65, 2048
    buffer_load_dwordx4 v11, s[36:39], s48 offen lds
    v_mfma_f32_16x16x32_bf16 v[172:175], a[116:119], a[36:39], v[172:175]
    ds_read_b128 a[108:111], v15 offset:26624
    v_mfma_f32_16x16x32_bf16 v[228:231], a[36:39], a[120:123], v[228:231]
    v_mfma_f32_16x16x32_bf16 v[120:123], a[112:115], a[40:43], v[120:123]
    v_mfma_f32_16x16x32_bf16 v[176:179], a[116:119], a[40:43], v[176:179]
    v_mfma_f32_16x16x32_bf16 v[232:235], a[40:43], a[120:123], v[232:235]
    v_mfma_f32_16x16x32_bf16 v[124:127], a[112:115], a[44:47], v[124:127]
    v_mfma_f32_16x16x32_bf16 v[180:183], a[116:119], a[44:47], v[180:183]
    s_add_u32 m0, s62, 49152
    s_add_u32 s48, s65, 100352
    buffer_load_dwordx4 v11, s[36:39], s48 offen lds
    v_mfma_f32_16x16x32_bf16 v[236:239], a[44:47], a[120:123], v[236:239]
    v_mfma_f32_16x16x32_bf16 v[128:131], a[112:115], a[48:51], v[128:131]
    v_mfma_f32_16x16x32_bf16 v[184:187], a[116:119], a[48:51], v[184:187]
    v_mfma_f32_16x16x32_bf16 v[240:243], a[48:51], a[120:123], v[240:243]
    v_mfma_f32_16x16x32_bf16 v[132:135], a[112:115], a[52:55], v[132:135]
    v_mfma_f32_16x16x32_bf16 v[188:191], a[116:119], a[52:55], v[188:191]
    v_mfma_f32_16x16x32_bf16 v[244:247], a[52:55], a[120:123], v[244:247]
    s_waitcnt lgkmcnt(0)
    s_waitcnt vmcnt(13)
    s_barrier
    v_mfma_f32_16x16x32_bf16 v[72:75], a[124:127], v[28:31], v[72:75]
    s_add_u32 s48, s63, 4
    s_and_b32 s48, s48, 7
    s_lshl_b32 s64, s48, 7
    s_mul_i32 s65, s48, 196608
    s_add_u32 s65, s65, s61
    s_add_u32 s66, s64, s60
    s_add_u32 s64, s64, s59
    s_add_u32 m0, s62, 53248
    s_mov_b32 s48, s66
    buffer_load_dwordx4 v10, s[32:35], s48 offen lds
    v_mfma_f32_16x16x32_bf16 v[76:79], a[128:131], v[28:31], v[76:79]
    ds_read_b64_tr_b16 a[112:113], v20 offset:0
    v_mfma_f32_16x16x32_bf16 v[80:83], v[28:31], a[132:135], v[80:83]
    v_mfma_f32_16x16x32_bf16 v[136:139], a[128:131], a[56:59], v[136:139]
    ds_read_b64_tr_b16 a[114:115], v20 offset:512
    v_mfma_f32_16x16x32_bf16 v[192:195], a[56:59], a[132:135], v[192:195]
    ds_read_b64_tr_b16 a[116:117], v20 offset:8192
    v_mfma_f32_16x16x32_bf16 v[84:87], a[124:127], a[60:63], v[84:87]
    v_mfma_f32_16x16x32_bf16 v[140:143], a[128:131], a[60:63], v[140:143]
    ds_read_b64_tr_b16 a[118:119], v20 offset:8704
    s_add_u32 m0, s62, 57344
    s_add_u32 s48, s64, 0
    buffer_load_dwordx4 v10, s[32:35], s48 offen lds
    v_mfma_f32_16x16x32_bf16 v[196:199], a[60:63], a[132:135], v[196:199]
    ds_read_b64_tr_b16 a[120:121], v20 offset:16384
    v_mfma_f32_16x16x32_bf16 v[88:91], a[124:127], a[64:67], v[88:91]
    v_mfma_f32_16x16x32_bf16 v[144:147], a[128:131], a[64:67], v[144:147]
    ds_read_b64_tr_b16 a[122:123], v20 offset:16896
    v_mfma_f32_16x16x32_bf16 v[200:203], a[64:67], a[132:135], v[200:203]
    ds_read_b128 a[0:3], v16 offset:0
    v_mfma_f32_16x16x32_bf16 v[92:95], a[124:127], a[68:71], v[92:95]
    v_mfma_f32_16x16x32_bf16 v[148:151], a[128:131], a[68:71], v[148:151]
    ds_read_b128 a[4:7], v16 offset:2048
    s_add_u32 m0, s62, 61440
    s_add_u32 s48, s64, 32768
    buffer_load_dwordx4 v10, s[32:35], s48 offen lds
    v_mfma_f32_16x16x32_bf16 v[204:207], a[68:71], a[132:135], v[204:207]
    ds_read_b128 a[8:11], v16 offset:4096
    v_mfma_f32_16x16x32_bf16 v[96:99], a[124:127], a[72:75], v[96:99]
    v_mfma_f32_16x16x32_bf16 v[152:155], a[128:131], a[72:75], v[152:155]
    ds_read_b128 a[12:15], v16 offset:6144
    v_mfma_f32_16x16x32_bf16 v[208:211], a[72:75], a[132:135], v[208:211]
    ds_read_b128 a[16:19], v16 offset:8192
    v_mfma_f32_16x16x32_bf16 v[100:103], a[124:127], a[76:79], v[100:103]
    v_mfma_f32_16x16x32_bf16 v[156:159], a[128:131], a[76:79], v[156:159]
    ds_read_b128 a[20:23], v16 offset:10240
    s_add_u32 m0, s62, 65536
    s_add_u32 s48, s64, 65536
    buffer_load_dwordx4 v10, s[32:35], s48 offen lds
    v_mfma_f32_16x16x32_bf16 v[212:215], a[76:79], a[132:135], v[212:215]
    v_mfma_f32_16x16x32_bf16 v[104:107], a[124:127], a[80:83], v[104:107]
    ds_read_b128 a[24:27], v16 offset:12288
    v_mfma_f32_16x16x32_bf16 v[160:163], a[128:131], a[80:83], v[160:163]
    ds_read_b128 a[28:31], v16 offset:14336
    s_waitcnt lgkmcnt(10)
    v_mfma_f32_16x16x32_bf16 v[216:219], a[80:83], a[132:135], v[216:219]
    v_mfma_f32_16x16x32_bf16 v[108:111], a[124:127], a[84:87], v[108:111]
    ds_read_b128 a[32:35], v16 offset:16384
    v_mfma_f32_16x16x32_bf16 v[164:167], a[128:131], a[84:87], v[164:167]
    ds_read_b128 a[36:39], v16 offset:18432
    v_mfma_f32_16x16x32_bf16 v[220:223], a[84:87], a[132:135], v[220:223]
    s_add_u32 m0, s62, 69632
    s_add_u32 s48, s64, 98304
    buffer_load_dwordx4 v10, s[32:35], s48 offen lds
    v_mfma_f32_16x16x32_bf16 v[112:115], a[124:127], a[88:91], v[112:115]
    ds_read_b128 a[40:43], v16 offset:20480
    v_mfma_f32_16x16x32_bf16 v[168:171], a[128:131], a[88:91], v[168:171]
    ds_read_b128 a[44:47], v16 offset:22528
    s_waitcnt lgkmcnt(10)
    v_mfma_f32_16x16x32_bf16 v[224:227], a[88:91], a[132:135], v[224:227]
    v_mfma_f32_16x16x32_bf16 v[116:119], a[124:127], a[92:95], v[116:119]
    ds_read_b128 a[48:51], v16 offset:24576
    v_mfma_f32_16x16x32_bf16 v[172:175], a[128:131], a[92:95], v[172:175]
    ds_read_b128 a[52:55], v16 offset:26624
    v_mfma_f32_16x16x32_bf16 v[228:231], a[92:95], a[132:135], v[228:231]
    s_add_u32 m0, s62, 73728
    s_add_u32 s48, s64, 131072
    buffer_load_dwordx4 v10, s[32:35], s48 offen lds
    v_mfma_f32_16x16x32_bf16 v[120:123], a[124:127], a[96:99], v[120:123]
    v_mfma_f32_16x16x32_bf16 v[176:179], a[128:131], a[96:99], v[176:179]
    v_mfma_f32_16x16x32_bf16 v[232:235], a[96:99], a[132:135], v[232:235]
    v_mfma_f32_16x16x32_bf16 v[124:127], a[124:127], a[100:103], v[124:127]
    v_mfma_f32_16x16x32_bf16 v[180:183], a[128:131], a[100:103], v[180:183]
    v_mfma_f32_16x16x32_bf16 v[236:239], a[100:103], a[132:135], v[236:239]
    s_add_u32 m0, s62, 77824
    s_add_u32 s48, s64, 163840
    buffer_load_dwordx4 v10, s[32:35], s48 offen lds
    v_mfma_f32_16x16x32_bf16 v[128:131], a[124:127], a[104:107], v[128:131]
    v_mfma_f32_16x16x32_bf16 v[184:187], a[128:131], a[104:107], v[184:187]
    v_mfma_f32_16x16x32_bf16 v[240:243], a[104:107], a[132:135], v[240:243]
    v_mfma_f32_16x16x32_bf16 v[132:135], a[124:127], a[108:111], v[132:135]
    v_mfma_f32_16x16x32_bf16 v[188:191], a[128:131], a[108:111], v[188:191]
    v_mfma_f32_16x16x32_bf16 v[244:247], a[108:111], a[132:135], v[244:247]
    v_mfma_f32_16x16x32_bf16 v[72:75], a[112:115], v[28:31], v[72:75]
    s_add_u32 m0, s62, 81920
    s_add_u32 s48, s65, 0
    buffer_load_dwordx4 v11, s[36:39], s48 offen lds
    v_mfma_f32_16x16x32_bf16 v[76:79], a[116:119], v[28:31], v[76:79]
    ds_read_b64_tr_b16 a[124:125], v20 offset:4096
    v_mfma_f32_16x16x32_bf16 v[80:83], v[28:31], a[120:123], v[80:83]
    v_mfma_f32_16x16x32_bf16 v[136:139], a[116:119], a[0:3], v[136:139]
    ds_read_b64_tr_b16 a[126:127], v20 offset:4608
    s_waitcnt lgkmcnt(10)
    v_mfma_f32_16x16x32_bf16 v[192:195], a[0:3], a[120:123], v[192:195]
    ds_read_b64_tr_b16 a[128:129], v20 offset:12288
    v_mfma_f32_16x16x32_bf16 v[84:87], a[112:115], a[4:7], v[84:87]
    v_mfma_f32_16x16x32_bf16 v[140:143], a[116:119], a[4:7], v[140:143]
    ds_read_b64_tr_b16 a[130:131], v20 offset:12800
    v_mfma_f32_16x16x32_bf16 v[196:199], a[4:7], a[120:123], v[196:199]
    ds_read_b64_tr_b16 a[132:133], v20 offset:20480
    s_add_u32 m0, s62, 86016
    s_add_u32 s48, s65, 98304
    buffer_load_dwordx4 v11, s[36:39], s48 offen lds
    v_mfma_f32_16x16x32_bf16 v[88:91], a[112:115], a[8:11], v[88:91]
    v_mfma_f32_16x16x32_bf16 v[144:147], a[116:119], a[8:11], v[144:147]
    ds_read_b64_tr_b16 a[134:135], v20 offset:20992
    s_waitcnt lgkmcnt(10)
    v_mfma_f32_16x16x32_bf16 v[200:203], a[8:11], a[120:123], v[200:203]
    ds_read_b128 a[56:59], v17 offset:0
    v_mfma_f32_16x16x32_bf16 v[92:95], a[112:115], a[12:15], v[92:95]
    v_mfma_f32_16x16x32_bf16 v[148:151], a[116:119], a[12:15], v[148:151]
    ds_read_b128 a[60:63], v17 offset:2048
    v_mfma_f32_16x16x32_bf16 v[204:207], a[12:15], a[120:123], v[204:207]
    ds_read_b128 a[64:67], v17 offset:4096
    v_mfma_f32_16x16x32_bf16 v[96:99], a[112:115], a[16:19], v[96:99]
    s_add_u32 m0, s62, 90112
    s_add_u32 s48, s65, 1024
    buffer_load_dwordx4 v11, s[36:39], s48 offen lds
    v_mfma_f32_16x16x32_bf16 v[152:155], a[116:119], a[16:19], v[152:155]
    ds_read_b128 a[68:71], v17 offset:6144
    s_waitcnt lgkmcnt(10)
    v_mfma_f32_16x16x32_bf16 v[208:211], a[16:19], a[120:123], v[208:211]
    ds_read_b128 a[72:75], v17 offset:8192
    v_mfma_f32_16x16x32_bf16 v[100:103], a[112:115], a[20:23], v[100:103]
    v_mfma_f32_16x16x32_bf16 v[156:159], a[116:119], a[20:23], v[156:159]
    ds_read_b128 a[76:79], v17 offset:10240
    v_mfma_f32_16x16x32_bf16 v[212:215], a[20:23], a[120:123], v[212:215]
    v_mfma_f32_16x16x32_bf16 v[104:107], a[112:115], a[24:27], v[104:107]
    ds_read_b128 a[80:83], v17 offset:12288
    v_mfma_f32_16x16x32_bf16 v[160:163], a[116:119], a[24:27], v[160:163]
    ds_read_b128 a[84:87], v17 offset:14336
    s_waitcnt lgkmcnt(10)
    s_add_u32 m0, s62, 94208
    s_add_u32 s48, s65, 99328
    buffer_load_dwordx4 v11, s[36:39], s48 offen lds
    v_mfma_f32_16x16x32_bf16 v[216:219], a[24:27], a[120:123], v[216:219]
    v_mfma_f32_16x16x32_bf16 v[108:111], a[112:115], a[28:31], v[108:111]
    ds_read_b128 a[88:91], v17 offset:16384
    v_mfma_f32_16x16x32_bf16 v[164:167], a[116:119], a[28:31], v[164:167]
    ds_read_b128 a[92:95], v17 offset:18432
    v_mfma_f32_16x16x32_bf16 v[220:223], a[28:31], a[120:123], v[220:223]
    v_mfma_f32_16x16x32_bf16 v[112:115], a[112:115], a[32:35], v[112:115]
    ds_read_b128 a[96:99], v17 offset:20480
    v_mfma_f32_16x16x32_bf16 v[168:171], a[116:119], a[32:35], v[168:171]
    ds_read_b128 a[100:103], v17 offset:22528
    s_waitcnt lgkmcnt(10)
    v_mfma_f32_16x16x32_bf16 v[224:227], a[32:35], a[120:123], v[224:227]
    v_mfma_f32_16x16x32_bf16 v[116:119], a[112:115], a[36:39], v[116:119]
    ds_read_b128 a[104:107], v17 offset:24576
    s_add_u32 m0, s62, 98304
    s_add_u32 s48, s65, 2048
    buffer_load_dwordx4 v11, s[36:39], s48 offen lds
    v_mfma_f32_16x16x32_bf16 v[172:175], a[116:119], a[36:39], v[172:175]
    ds_read_b128 a[108:111], v17 offset:26624
    v_mfma_f32_16x16x32_bf16 v[228:231], a[36:39], a[120:123], v[228:231]
    v_mfma_f32_16x16x32_bf16 v[120:123], a[112:115], a[40:43], v[120:123]
    v_mfma_f32_16x16x32_bf16 v[176:179], a[116:119], a[40:43], v[176:179]
    v_mfma_f32_16x16x32_bf16 v[232:235], a[40:43], a[120:123], v[232:235]
    v_mfma_f32_16x16x32_bf16 v[124:127], a[112:115], a[44:47], v[124:127]
    v_mfma_f32_16x16x32_bf16 v[180:183], a[116:119], a[44:47], v[180:183]
    s_add_u32 m0, s62, 102400
    s_add_u32 s48, s65, 100352
    buffer_load_dwordx4 v11, s[36:39], s48 offen lds
    v_mfma_f32_16x16x32_bf16 v[236:239], a[44:47], a[120:123], v[236:239]
    v_mfma_f32_16x16x32_bf16 v[128:131], a[112:115], a[48:51], v[128:131]
    v_mfma_f32_16x16x32_bf16 v[184:187], a[116:119], a[48:51], v[184:187]
    v_mfma_f32_16x16x32_bf16 v[240:243], a[48:51], a[120:123], v[240:243]
    v_mfma_f32_16x16x32_bf16 v[132:135], a[112:115], a[52:55], v[132:135]
    v_mfma_f32_16x16x32_bf16 v[188:191], a[116:119], a[52:55], v[188:191]
    v_mfma_f32_16x16x32_bf16 v[244:247], a[52:55], a[120:123], v[244:247]
    s_waitcnt lgkmcnt(0)
    s_waitcnt vmcnt(13)
    s_barrier
    v_mfma_f32_16x16x32_bf16 v[72:75], a[124:127], v[28:31], v[72:75]
    s_add_u32 s48, s63, 5
    s_and_b32 s48, s48, 7
    s_lshl_b32 s64, s48, 7
    s_mul_i32 s65, s48, 196608
    s_add_u32 s65, s65, s61
    s_add_u32 s66, s64, s60
    s_add_u32 s64, s64, s59
    s_add_u32 m0, s62, 106496
    s_mov_b32 s48, s66
    buffer_load_dwordx4 v10, s[32:35], s48 offen lds
    v_mfma_f32_16x16x32_bf16 v[76:79], a[128:131], v[28:31], v[76:79]
    ds_read_b64_tr_b16 a[112:113], v18 offset:0
    v_mfma_f32_16x16x32_bf16 v[80:83], v[28:31], a[132:135], v[80:83]
    v_mfma_f32_16x16x32_bf16 v[136:139], a[128:131], a[56:59], v[136:139]
    ds_read_b64_tr_b16 a[114:115], v18 offset:512
    v_mfma_f32_16x16x32_bf16 v[192:195], a[56:59], a[132:135], v[192:195]
    ds_read_b64_tr_b16 a[116:117], v18 offset:8192
    v_mfma_f32_16x16x32_bf16 v[84:87], a[124:127], a[60:63], v[84:87]
    v_mfma_f32_16x16x32_bf16 v[140:143], a[128:131], a[60:63], v[140:143]
    ds_read_b64_tr_b16 a[118:119], v18 offset:8704
    s_add_u32 m0, s62, 110592
    s_add_u32 s48, s64, 0
    buffer_load_dwordx4 v10, s[32:35], s48 offen lds
    v_mfma_f32_16x16x32_bf16 v[196:199], a[60:63], a[132:135], v[196:199]
    ds_read_b64_tr_b16 a[120:121], v18 offset:16384
    v_mfma_f32_16x16x32_bf16 v[88:91], a[124:127], a[64:67], v[88:91]
    v_mfma_f32_16x16x32_bf16 v[144:147], a[128:131], a[64:67], v[144:147]
    ds_read_b64_tr_b16 a[122:123], v18 offset:16896
    v_mfma_f32_16x16x32_bf16 v[200:203], a[64:67], a[132:135], v[200:203]
    ds_read_b128 a[0:3], v12 offset:0
    v_mfma_f32_16x16x32_bf16 v[92:95], a[124:127], a[68:71], v[92:95]
    v_mfma_f32_16x16x32_bf16 v[148:151], a[128:131], a[68:71], v[148:151]
    ds_read_b128 a[4:7], v12 offset:2048
    s_add_u32 m0, s62, 114688
    s_add_u32 s48, s64, 32768
    buffer_load_dwordx4 v10, s[32:35], s48 offen lds
    v_mfma_f32_16x16x32_bf16 v[204:207], a[68:71], a[132:135], v[204:207]
    ds_read_b128 a[8:11], v12 offset:4096
    v_mfma_f32_16x16x32_bf16 v[96:99], a[124:127], a[72:75], v[96:99]
    v_mfma_f32_16x16x32_bf16 v[152:155], a[128:131], a[72:75], v[152:155]
    ds_read_b128 a[12:15], v12 offset:6144
    v_mfma_f32_16x16x32_bf16 v[208:211], a[72:75], a[132:135], v[208:211]
    ds_read_b128 a[16:19], v12 offset:8192
    v_mfma_f32_16x16x32_bf16 v[100:103], a[124:127], a[76:79], v[100:103]
    v_mfma_f32_16x16x32_bf16 v[156:159], a[128:131], a[76:79], v[156:159]
    ds_read_b128 a[20:23], v12 offset:10240
    s_add_u32 m0, s62, 118784
    s_add_u32 s48, s64, 65536
    buffer_load_dwordx4 v10, s[32:35], s48 offen lds
    v_mfma_f32_16x16x32_bf16 v[212:215], a[76:79], a[132:135], v[212:215]
    v_mfma_f32_16x16x32_bf16 v[104:107], a[124:127], a[80:83], v[104:107]
    ds_read_b128 a[24:27], v12 offset:12288
    v_mfma_f32_16x16x32_bf16 v[160:163], a[128:131], a[80:83], v[160:163]
    ds_read_b128 a[28:31], v12 offset:14336
    s_waitcnt lgkmcnt(10)
    v_mfma_f32_16x16x32_bf16 v[216:219], a[80:83], a[132:135], v[216:219]
    v_mfma_f32_16x16x32_bf16 v[108:111], a[124:127], a[84:87], v[108:111]
    ds_read_b128 a[32:35], v12 offset:16384
    v_mfma_f32_16x16x32_bf16 v[164:167], a[128:131], a[84:87], v[164:167]
    ds_read_b128 a[36:39], v12 offset:18432
    v_mfma_f32_16x16x32_bf16 v[220:223], a[84:87], a[132:135], v[220:223]
    s_add_u32 m0, s62, 122880
    s_add_u32 s48, s64, 98304
    buffer_load_dwordx4 v10, s[32:35], s48 offen lds
    v_mfma_f32_16x16x32_bf16 v[112:115], a[124:127], a[88:91], v[112:115]
    ds_read_b128 a[40:43], v12 offset:20480
    v_mfma_f32_16x16x32_bf16 v[168:171], a[128:131], a[88:91], v[168:171]
    ds_read_b128 a[44:47], v12 offset:22528
    s_waitcnt lgkmcnt(10)
    v_mfma_f32_16x16x32_bf16 v[224:227], a[88:91], a[132:135], v[224:227]
    v_mfma_f32_16x16x32_bf16 v[116:119], a[124:127], a[92:95], v[116:119]
    ds_read_b128 a[48:51], v12 offset:24576
    v_mfma_f32_16x16x32_bf16 v[172:175], a[128:131], a[92:95], v[172:175]
    ds_read_b128 a[52:55], v12 offset:26624
    v_mfma_f32_16x16x32_bf16 v[228:231], a[92:95], a[132:135], v[228:231]
    s_add_u32 m0, s62, 126976
    s_add_u32 s48, s64, 131072
    buffer_load_dwordx4 v10, s[32:35], s48 offen lds
    v_mfma_f32_16x16x32_bf16 v[120:123], a[124:127], a[96:99], v[120:123]
    v_mfma_f32_16x16x32_bf16 v[176:179], a[128:131], a[96:99], v[176:179]
    v_mfma_f32_16x16x32_bf16 v[232:235], a[96:99], a[132:135], v[232:235]
    v_mfma_f32_16x16x32_bf16 v[124:127], a[124:127], a[100:103], v[124:127]
    v_mfma_f32_16x16x32_bf16 v[180:183], a[128:131], a[100:103], v[180:183]
    v_mfma_f32_16x16x32_bf16 v[236:239], a[100:103], a[132:135], v[236:239]
    s_add_u32 m0, s62, 131072
    s_add_u32 s48, s64, 163840
    buffer_load_dwordx4 v10, s[32:35], s48 offen lds
    v_mfma_f32_16x16x32_bf16 v[128:131], a[124:127], a[104:107], v[128:131]
    v_mfma_f32_16x16x32_bf16 v[184:187], a[128:131], a[104:107], v[184:187]
    v_mfma_f32_16x16x32_bf16 v[240:243], a[104:107], a[132:135], v[240:243]
    v_mfma_f32_16x16x32_bf16 v[132:135], a[124:127], a[108:111], v[132:135]
    v_mfma_f32_16x16x32_bf16 v[188:191], a[128:131], a[108:111], v[188:191]
    v_mfma_f32_16x16x32_bf16 v[244:247], a[108:111], a[132:135], v[244:247]
    v_mfma_f32_16x16x32_bf16 v[72:75], a[112:115], v[28:31], v[72:75]
    s_add_u32 m0, s62, 135168
    s_add_u32 s48, s65, 0
    buffer_load_dwordx4 v11, s[36:39], s48 offen lds
    v_mfma_f32_16x16x32_bf16 v[76:79], a[116:119], v[28:31], v[76:79]
    ds_read_b64_tr_b16 a[124:125], v18 offset:4096
    v_mfma_f32_16x16x32_bf16 v[80:83], v[28:31], a[120:123], v[80:83]
    v_mfma_f32_16x16x32_bf16 v[136:139], a[116:119], a[0:3], v[136:139]
    ds_read_b64_tr_b16 a[126:127], v18 offset:4608
    s_waitcnt lgkmcnt(10)
    v_mfma_f32_16x16x32_bf16 v[192:195], a[0:3], a[120:123], v[192:195]
    ds_read_b64_tr_b16 a[128:129], v18 offset:12288
    v_mfma_f32_16x16x32_bf16 v[84:87], a[112:115], a[4:7], v[84:87]
    v_mfma_f32_16x16x32_bf16 v[140:143], a[116:119], a[4:7], v[140:143]
    ds_read_b64_tr_b16 a[130:131], v18 offset:12800
    v_mfma_f32_16x16x32_bf16 v[196:199], a[4:7], a[120:123], v[196:199]
    ds_read_b64_tr_b16 a[132:133], v18 offset:20480
    s_add_u32 m0, s62, 139264
    s_add_u32 s48, s65, 98304
    buffer_load_dwordx4 v11, s[36:39], s48 offen lds
    v_mfma_f32_16x16x32_bf16 v[88:91], a[112:115], a[8:11], v[88:91]
    v_mfma_f32_16x16x32_bf16 v[144:147], a[116:119], a[8:11], v[144:147]
    ds_read_b64_tr_b16 a[134:135], v18 offset:20992
    s_waitcnt lgkmcnt(10)
    v_mfma_f32_16x16x32_bf16 v[200:203], a[8:11], a[120:123], v[200:203]
    ds_read_b128 a[56:59], v13 offset:0
    v_mfma_f32_16x16x32_bf16 v[92:95], a[112:115], a[12:15], v[92:95]
    v_mfma_f32_16x16x32_bf16 v[148:151], a[116:119], a[12:15], v[148:151]
    ds_read_b128 a[60:63], v13 offset:2048
    v_mfma_f32_16x16x32_bf16 v[204:207], a[12:15], a[120:123], v[204:207]
    ds_read_b128 a[64:67], v13 offset:4096
    v_mfma_f32_16x16x32_bf16 v[96:99], a[112:115], a[16:19], v[96:99]
    s_add_u32 m0, s62, 143360
    s_add_u32 s48, s65, 1024
    buffer_load_dwordx4 v11, s[36:39], s48 offen lds
    v_mfma_f32_16x16x32_bf16 v[152:155], a[116:119], a[16:19], v[152:155]
    ds_read_b128 a[68:71], v13 offset:6144
    s_waitcnt lgkmcnt(10)
    v_mfma_f32_16x16x32_bf16 v[208:211], a[16:19], a[120:123], v[208:211]
    ds_read_b128 a[72:75], v13 offset:8192
    v_mfma_f32_16x16x32_bf16 v[100:103], a[112:115], a[20:23], v[100:103]
    v_mfma_f32_16x16x32_bf16 v[156:159], a[116:119], a[20:23], v[156:159]
    ds_read_b128 a[76:79], v13 offset:10240
    v_mfma_f32_16x16x32_bf16 v[212:215], a[20:23], a[120:123], v[212:215]
    v_mfma_f32_16x16x32_bf16 v[104:107], a[112:115], a[24:27], v[104:107]
    ds_read_b128 a[80:83], v13 offset:12288
    v_mfma_f32_16x16x32_bf16 v[160:163], a[116:119], a[24:27], v[160:163]
    ds_read_b128 a[84:87], v13 offset:14336
    s_waitcnt lgkmcnt(10)
    s_add_u32 m0, s62, 147456
    s_add_u32 s48, s65, 99328
    buffer_load_dwordx4 v11, s[36:39], s48 offen lds
    v_mfma_f32_16x16x32_bf16 v[216:219], a[24:27], a[120:123], v[216:219]
    v_mfma_f32_16x16x32_bf16 v[108:111], a[112:115], a[28:31], v[108:111]
    ds_read_b128 a[88:91], v13 offset:16384
    v_mfma_f32_16x16x32_bf16 v[164:167], a[116:119], a[28:31], v[164:167]
    ds_read_b128 a[92:95], v13 offset:18432
    v_mfma_f32_16x16x32_bf16 v[220:223], a[28:31], a[120:123], v[220:223]
    v_mfma_f32_16x16x32_bf16 v[112:115], a[112:115], a[32:35], v[112:115]
    ds_read_b128 a[96:99], v13 offset:20480
    v_mfma_f32_16x16x32_bf16 v[168:171], a[116:119], a[32:35], v[168:171]
    ds_read_b128 a[100:103], v13 offset:22528
    s_waitcnt lgkmcnt(10)
    v_mfma_f32_16x16x32_bf16 v[224:227], a[32:35], a[120:123], v[224:227]
    v_mfma_f32_16x16x32_bf16 v[116:119], a[112:115], a[36:39], v[116:119]
    ds_read_b128 a[104:107], v13 offset:24576
    s_add_u32 m0, s62, 151552
    s_add_u32 s48, s65, 2048
    buffer_load_dwordx4 v11, s[36:39], s48 offen lds
    v_mfma_f32_16x16x32_bf16 v[172:175], a[116:119], a[36:39], v[172:175]
    ds_read_b128 a[108:111], v13 offset:26624
    v_mfma_f32_16x16x32_bf16 v[228:231], a[36:39], a[120:123], v[228:231]
    v_mfma_f32_16x16x32_bf16 v[120:123], a[112:115], a[40:43], v[120:123]
    v_mfma_f32_16x16x32_bf16 v[176:179], a[116:119], a[40:43], v[176:179]
    v_mfma_f32_16x16x32_bf16 v[232:235], a[40:43], a[120:123], v[232:235]
    v_mfma_f32_16x16x32_bf16 v[124:127], a[112:115], a[44:47], v[124:127]
    v_mfma_f32_16x16x32_bf16 v[180:183], a[116:119], a[44:47], v[180:183]
    s_add_u32 m0, s62, 155648
    s_add_u32 s48, s65, 100352
    buffer_load_dwordx4 v11, s[36:39], s48 offen lds
    v_mfma_f32_16x16x32_bf16 v[236:239], a[44:47], a[120:123], v[236:239]
    v_mfma_f32_16x16x32_bf16 v[128:131], a[112:115], a[48:51], v[128:131]
    v_mfma_f32_16x16x32_bf16 v[184:187], a[116:119], a[48:51], v[184:187]
    v_mfma_f32_16x16x32_bf16 v[240:243], a[48:51], a[120:123], v[240:243]
    v_mfma_f32_16x16x32_bf16 v[132:135], a[112:115], a[52:55], v[132:135]
    v_mfma_f32_16x16x32_bf16 v[188:191], a[116:119], a[52:55], v[188:191]
    v_mfma_f32_16x16x32_bf16 v[244:247], a[52:55], a[120:123], v[244:247]
    s_waitcnt lgkmcnt(0)
    s_waitcnt vmcnt(13)
    s_barrier
    v_mfma_f32_16x16x32_bf16 v[72:75], a[124:127], v[28:31], v[72:75]
    s_add_u32 s48, s63, 6
    s_and_b32 s48, s48, 7
    s_lshl_b32 s64, s48, 7
    s_mul_i32 s65, s48, 196608
    s_add_u32 s65, s65, s61
    s_add_u32 s66, s64, s60
    s_add_u32 s64, s64, s59
    s_add_u32 m0, s62, 0
    s_mov_b32 s48, s66
    buffer_load_dwordx4 v10, s[32:35], s48 offen lds
    v_mfma_f32_16x16x32_bf16 v[76:79], a[128:131], v[28:31], v[76:79]
    ds_read_b64_tr_b16 a[112:113], v19 offset:0
    v_mfma_f32_16x16x32_bf16 v[80:83], v[28:31], a[132:135], v[80:83]
    v_mfma_f32_16x16x32_bf16 v[136:139], a[128:131], a[56:59], v[136:139]
    ds_read_b64_tr_b16 a[114:115], v19 offset:512
    v_mfma_f32_16x16x32_bf16 v[192:195], a[56:59], a[132:135], v[192:195]
    ds_read_b64_tr_b16 a[116:117], v19 offset:8192
    v_mfma_f32_16x16x32_bf16 v[84:87], a[124:127], a[60:63], v[84:87]
    v_mfma_f32_16x16x32_bf16 v[140:143], a[128:131], a[60:63], v[140:143]
    ds_read_b64_tr_b16 a[118:119], v19 offset:8704
    s_add_u32 m0, s62, 4096
    s_add_u32 s48, s64, 0
    buffer_load_dwordx4 v10, s[32:35], s48 offen lds
    v_mfma_f32_16x16x32_bf16 v[196:199], a[60:63], a[132:135], v[196:199]
    ds_read_b64_tr_b16 a[120:121], v19 offset:16384
    v_mfma_f32_16x16x32_bf16 v[88:91], a[124:127], a[64:67], v[88:91]
    v_mfma_f32_16x16x32_bf16 v[144:147], a[128:131], a[64:67], v[144:147]
    ds_read_b64_tr_b16 a[122:123], v19 offset:16896
    v_mfma_f32_16x16x32_bf16 v[200:203], a[64:67], a[132:135], v[200:203]
    ds_read_b128 a[0:3], v14 offset:0
    v_mfma_f32_16x16x32_bf16 v[92:95], a[124:127], a[68:71], v[92:95]
    v_mfma_f32_16x16x32_bf16 v[148:151], a[128:131], a[68:71], v[148:151]
    ds_read_b128 a[4:7], v14 offset:2048
    s_add_u32 m0, s62, 8192
    s_add_u32 s48, s64, 32768
    buffer_load_dwordx4 v10, s[32:35], s48 offen lds
    v_mfma_f32_16x16x32_bf16 v[204:207], a[68:71], a[132:135], v[204:207]
    ds_read_b128 a[8:11], v14 offset:4096
    v_mfma_f32_16x16x32_bf16 v[96:99], a[124:127], a[72:75], v[96:99]
    v_mfma_f32_16x16x32_bf16 v[152:155], a[128:131], a[72:75], v[152:155]
    ds_read_b128 a[12:15], v14 offset:6144
    v_mfma_f32_16x16x32_bf16 v[208:211], a[72:75], a[132:135], v[208:211]
    ds_read_b128 a[16:19], v14 offset:8192
    v_mfma_f32_16x16x32_bf16 v[100:103], a[124:127], a[76:79], v[100:103]
    v_mfma_f32_16x16x32_bf16 v[156:159], a[128:131], a[76:79], v[156:159]
    ds_read_b128 a[20:23], v14 offset:10240
    s_add_u32 m0, s62, 12288
    s_add_u32 s48, s64, 65536
    buffer_load_dwordx4 v10, s[32:35], s48 offen lds
    v_mfma_f32_16x16x32_bf16 v[212:215], a[76:79], a[132:135], v[212:215]
    v_mfma_f32_16x16x32_bf16 v[104:107], a[124:127], a[80:83], v[104:107]
    ds_read_b128 a[24:27], v14 offset:12288
    v_mfma_f32_16x16x32_bf16 v[160:163], a[128:131], a[80:83], v[160:163]
    ds_read_b128 a[28:31], v14 offset:14336
    s_waitcnt lgkmcnt(10)
    v_mfma_f32_16x16x32_bf16 v[216:219], a[80:83], a[132:135], v[216:219]
    v_mfma_f32_16x16x32_bf16 v[108:111], a[124:127], a[84:87], v[108:111]
    ds_read_b128 a[32:35], v14 offset:16384
    v_mfma_f32_16x16x32_bf16 v[164:167], a[128:131], a[84:87], v[164:167]
    ds_read_b128 a[36:39], v14 offset:18432
    v_mfma_f32_16x16x32_bf16 v[220:223], a[84:87], a[132:135], v[220:223]
    s_add_u32 m0, s62, 16384
    s_add_u32 s48, s64, 98304
    buffer_load_dwordx4 v10, s[32:35], s48 offen lds
    v_mfma_f32_16x16x32_bf16 v[112:115], a[124:127], a[88:91], v[112:115]
    ds_read_b128 a[40:43], v14 offset:20480
    v_mfma_f32_16x16x32_bf16 v[168:171], a[128:131], a[88:91], v[168:171]
    ds_read_b128 a[44:47], v14 offset:22528
    s_waitcnt lgkmcnt(10)
    v_mfma_f32_16x16x32_bf16 v[224:227], a[88:91], a[132:135], v[224:227]
    v_mfma_f32_16x16x32_bf16 v[116:119], a[124:127], a[92:95], v[116:119]
    ds_read_b128 a[48:51], v14 offset:24576
    v_mfma_f32_16x16x32_bf16 v[172:175], a[128:131], a[92:95], v[172:175]
    ds_read_b128 a[52:55], v14 offset:26624
    v_mfma_f32_16x16x32_bf16 v[228:231], a[92:95], a[132:135], v[228:231]
    s_add_u32 m0, s62, 20480
    s_add_u32 s48, s64, 131072
    buffer_load_dwordx4 v10, s[32:35], s48 offen lds
    v_mfma_f32_16x16x32_bf16 v[120:123], a[124:127], a[96:99], v[120:123]
    v_mfma_f32_16x16x32_bf16 v[176:179], a[128:131], a[96:99], v[176:179]
    v_mfma_f32_16x16x32_bf16 v[232:235], a[96:99], a[132:135], v[232:235]
    v_mfma_f32_16x16x32_bf16 v[124:127], a[124:127], a[100:103], v[124:127]
    v_mfma_f32_16x16x32_bf16 v[180:183], a[128:131], a[100:103], v[180:183]
    v_mfma_f32_16x16x32_bf16 v[236:239], a[100:103], a[132:135], v[236:239]
    s_add_u32 m0, s62, 24576
    s_add_u32 s48, s64, 163840
    buffer_load_dwordx4 v10, s[32:35], s48 offen lds
    v_mfma_f32_16x16x32_bf16 v[128:131], a[124:127], a[104:107], v[128:131]
    v_mfma_f32_16x16x32_bf16 v[184:187], a[128:131], a[104:107], v[184:187]
    v_mfma_f32_16x16x32_bf16 v[240:243], a[104:107], a[132:135], v[240:243]
    v_mfma_f32_16x16x32_bf16 v[132:135], a[124:127], a[108:111], v[132:135]
    v_mfma_f32_16x16x32_bf16 v[188:191], a[128:131], a[108:111], v[188:191]
    v_mfma_f32_16x16x32_bf16 v[244:247], a[108:111], a[132:135], v[244:247]
    v_mfma_f32_16x16x32_bf16 v[72:75], a[112:115], v[28:31], v[72:75]
    s_add_u32 m0, s62, 28672
    s_add_u32 s48, s65, 0
    buffer_load_dwordx4 v11, s[36:39], s48 offen lds
    v_mfma_f32_16x16x32_bf16 v[76:79], a[116:119], v[28:31], v[76:79]
    ds_read_b64_tr_b16 a[124:125], v19 offset:4096
    v_mfma_f32_16x16x32_bf16 v[80:83], v[28:31], a[120:123], v[80:83]
    v_mfma_f32_16x16x32_bf16 v[136:139], a[116:119], a[0:3], v[136:139]
    ds_read_b64_tr_b16 a[126:127], v19 offset:4608
    s_waitcnt lgkmcnt(10)
    v_mfma_f32_16x16x32_bf16 v[192:195], a[0:3], a[120:123], v[192:195]
    ds_read_b64_tr_b16 a[128:129], v19 offset:12288
    v_mfma_f32_16x16x32_bf16 v[84:87], a[112:115], a[4:7], v[84:87]
    v_mfma_f32_16x16x32_bf16 v[140:143], a[116:119], a[4:7], v[140:143]
    ds_read_b64_tr_b16 a[130:131], v19 offset:12800
    v_mfma_f32_16x16x32_bf16 v[196:199], a[4:7], a[120:123], v[196:199]
    ds_read_b64_tr_b16 a[132:133], v19 offset:20480
    s_add_u32 m0, s62, 32768
    s_add_u32 s48, s65, 98304
    buffer_load_dwordx4 v11, s[36:39], s48 offen lds
    v_mfma_f32_16x16x32_bf16 v[88:91], a[112:115], a[8:11], v[88:91]
    v_mfma_f32_16x16x32_bf16 v[144:147], a[116:119], a[8:11], v[144:147]
    ds_read_b64_tr_b16 a[134:135], v19 offset:20992
    s_waitcnt lgkmcnt(10)
    v_mfma_f32_16x16x32_bf16 v[200:203], a[8:11], a[120:123], v[200:203]
    ds_read_b128 a[56:59], v15 offset:0
    v_mfma_f32_16x16x32_bf16 v[92:95], a[112:115], a[12:15], v[92:95]
    v_mfma_f32_16x16x32_bf16 v[148:151], a[116:119], a[12:15], v[148:151]
    ds_read_b128 a[60:63], v15 offset:2048
    v_mfma_f32_16x16x32_bf16 v[204:207], a[12:15], a[120:123], v[204:207]
    ds_read_b128 a[64:67], v15 offset:4096
    v_mfma_f32_16x16x32_bf16 v[96:99], a[112:115], a[16:19], v[96:99]
    s_add_u32 m0, s62, 36864
    s_add_u32 s48, s65, 1024
    buffer_load_dwordx4 v11, s[36:39], s48 offen lds
    v_mfma_f32_16x16x32_bf16 v[152:155], a[116:119], a[16:19], v[152:155]
    ds_read_b128 a[68:71], v15 offset:6144
    s_waitcnt lgkmcnt(10)
    v_mfma_f32_16x16x32_bf16 v[208:211], a[16:19], a[120:123], v[208:211]
    ds_read_b128 a[72:75], v15 offset:8192
    v_mfma_f32_16x16x32_bf16 v[100:103], a[112:115], a[20:23], v[100:103]
    v_mfma_f32_16x16x32_bf16 v[156:159], a[116:119], a[20:23], v[156:159]
    ds_read_b128 a[76:79], v15 offset:10240
    v_mfma_f32_16x16x32_bf16 v[212:215], a[20:23], a[120:123], v[212:215]
    v_mfma_f32_16x16x32_bf16 v[104:107], a[112:115], a[24:27], v[104:107]
    ds_read_b128 a[80:83], v15 offset:12288
    v_mfma_f32_16x16x32_bf16 v[160:163], a[116:119], a[24:27], v[160:163]
    ds_read_b128 a[84:87], v15 offset:14336
    s_waitcnt lgkmcnt(10)
    s_add_u32 m0, s62, 40960
    s_add_u32 s48, s65, 99328
    buffer_load_dwordx4 v11, s[36:39], s48 offen lds
    v_mfma_f32_16x16x32_bf16 v[216:219], a[24:27], a[120:123], v[216:219]
    v_mfma_f32_16x16x32_bf16 v[108:111], a[112:115], a[28:31], v[108:111]
    ds_read_b128 a[88:91], v15 offset:16384
    v_mfma_f32_16x16x32_bf16 v[164:167], a[116:119], a[28:31], v[164:167]
    ds_read_b128 a[92:95], v15 offset:18432
    v_mfma_f32_16x16x32_bf16 v[220:223], a[28:31], a[120:123], v[220:223]
    v_mfma_f32_16x16x32_bf16 v[112:115], a[112:115], a[32:35], v[112:115]
    ds_read_b128 a[96:99], v15 offset:20480
    v_mfma_f32_16x16x32_bf16 v[168:171], a[116:119], a[32:35], v[168:171]
    ds_read_b128 a[100:103], v15 offset:22528
    s_waitcnt lgkmcnt(10)
    v_mfma_f32_16x16x32_bf16 v[224:227], a[32:35], a[120:123], v[224:227]
    v_mfma_f32_16x16x32_bf16 v[116:119], a[112:115], a[36:39], v[116:119]
    ds_read_b128 a[104:107], v15 offset:24576
    s_add_u32 m0, s62, 45056
    s_add_u32 s48, s65, 2048
    buffer_load_dwordx4 v11, s[36:39], s48 offen lds
    v_mfma_f32_16x16x32_bf16 v[172:175], a[116:119], a[36:39], v[172:175]
    ds_read_b128 a[108:111], v15 offset:26624
    v_mfma_f32_16x16x32_bf16 v[228:231], a[36:39], a[120:123], v[228:231]
    v_mfma_f32_16x16x32_bf16 v[120:123], a[112:115], a[40:43], v[120:123]
    v_mfma_f32_16x16x32_bf16 v[176:179], a[116:119], a[40:43], v[176:179]
    v_mfma_f32_16x16x32_bf16 v[232:235], a[40:43], a[120:123], v[232:235]
    v_mfma_f32_16x16x32_bf16 v[124:127], a[112:115], a[44:47], v[124:127]
    v_mfma_f32_16x16x32_bf16 v[180:183], a[116:119], a[44:47], v[180:183]
    s_add_u32 m0, s62, 49152
    s_add_u32 s48, s65, 100352
    buffer_load_dwordx4 v11, s[36:39], s48 offen lds
    v_mfma_f32_16x16x32_bf16 v[236:239], a[44:47], a[120:123], v[236:239]
    v_mfma_f32_16x16x32_bf16 v[128:131], a[112:115], a[48:51], v[128:131]
    v_mfma_f32_16x16x32_bf16 v[184:187], a[116:119], a[48:51], v[184:187]
    v_mfma_f32_16x16x32_bf16 v[240:243], a[48:51], a[120:123], v[240:243]
    v_mfma_f32_16x16x32_bf16 v[132:135], a[112:115], a[52:55], v[132:135]
    v_mfma_f32_16x16x32_bf16 v[188:191], a[116:119], a[52:55], v[188:191]
    v_mfma_f32_16x16x32_bf16 v[244:247], a[52:55], a[120:123], v[244:247]
    s_waitcnt lgkmcnt(0)
    s_waitcnt vmcnt(13)
    s_barrier
    v_mfma_f32_16x16x32_bf16 v[72:75], a[124:127], v[28:31], v[72:75]
    s_add_u32 s48, s63, 7
    s_and_b32 s48, s48, 7
    s_lshl_b32 s64, s48, 7
    s_mul_i32 s65, s48, 196608
    s_add_u32 s65, s65, s61
    s_add_u32 s66, s64, s60
    s_add_u32 s64, s64, s59
    s_add_u32 m0, s62, 53248
    s_mov_b32 s48, s66
    buffer_load_dwordx4 v10, s[32:35], s48 offen lds
    v_mfma_f32_16x16x32_bf16 v[76:79], a[128:131], v[28:31], v[76:79]
    ds_read_b64_tr_b16 a[112:113], v20 offset:0
    v_mfma_f32_16x16x32_bf16 v[80:83], v[28:31], a[132:135], v[80:83]
    v_mfma_f32_16x16x32_bf16 v[136:139], a[128:131], a[56:59], v[136:139]
    ds_read_b64_tr_b16 a[114:115], v20 offset:512
    v_mfma_f32_16x16x32_bf16 v[192:195], a[56:59], a[132:135], v[192:195]
    ds_read_b64_tr_b16 a[116:117], v20 offset:8192
    v_mfma_f32_16x16x32_bf16 v[84:87], a[124:127], a[60:63], v[84:87]
    v_mfma_f32_16x16x32_bf16 v[140:143], a[128:131], a[60:63], v[140:143]
    ds_read_b64_tr_b16 a[118:119], v20 offset:8704
    s_add_u32 m0, s62, 57344
    s_add_u32 s48, s64, 0
    buffer_load_dwordx4 v10, s[32:35], s48 offen lds
    v_mfma_f32_16x16x32_bf16 v[196:199], a[60:63], a[132:135], v[196:199]
    ds_read_b64_tr_b16 a[120:121], v20 offset:16384
    v_mfma_f32_16x16x32_bf16 v[88:91], a[124:127], a[64:67], v[88:91]
    v_mfma_f32_16x16x32_bf16 v[144:147], a[128:131], a[64:67], v[144:147]
    ds_read_b64_tr_b16 a[122:123], v20 offset:16896
    v_mfma_f32_16x16x32_bf16 v[200:203], a[64:67], a[132:135], v[200:203]
    ds_read_b128 a[0:3], v16 offset:0
    v_mfma_f32_16x16x32_bf16 v[92:95], a[124:127], a[68:71], v[92:95]
    v_mfma_f32_16x16x32_bf16 v[148:151], a[128:131], a[68:71], v[148:151]
    ds_read_b128 a[4:7], v16 offset:2048
    s_add_u32 m0, s62, 61440
    s_add_u32 s48, s64, 32768
    buffer_load_dwordx4 v10, s[32:35], s48 offen lds
    v_mfma_f32_16x16x32_bf16 v[204:207], a[68:71], a[132:135], v[204:207]
    ds_read_b128 a[8:11], v16 offset:4096
    v_mfma_f32_16x16x32_bf16 v[96:99], a[124:127], a[72:75], v[96:99]
    v_mfma_f32_16x16x32_bf16 v[152:155], a[128:131], a[72:75], v[152:155]
    ds_read_b128 a[12:15], v16 offset:6144
    v_mfma_f32_16x16x32_bf16 v[208:211], a[72:75], a[132:135], v[208:211]
    ds_read_b128 a[16:19], v16 offset:8192
    v_mfma_f32_16x16x32_bf16 v[100:103], a[124:127], a[76:79], v[100:103]
    v_mfma_f32_16x16x32_bf16 v[156:159], a[128:131], a[76:79], v[156:159]
    ds_read_b128 a[20:23], v16 offset:10240
    s_add_u32 m0, s62, 65536
    s_add_u32 s48, s64, 65536
    buffer_load_dwordx4 v10, s[32:35], s48 offen lds
    v_mfma_f32_16x16x32_bf16 v[212:215], a[76:79], a[132:135], v[212:215]
    v_mfma_f32_16x16x32_bf16 v[104:107], a[124:127], a[80:83], v[104:107]
    ds_read_b128 a[24:27], v16 offset:12288
    v_mfma_f32_16x16x32_bf16 v[160:163], a[128:131], a[80:83], v[160:163]
    ds_read_b128 a[28:31], v16 offset:14336
    s_waitcnt lgkmcnt(10)
    v_mfma_f32_16x16x32_bf16 v[216:219], a[80:83], a[132:135], v[216:219]
    v_mfma_f32_16x16x32_bf16 v[108:111], a[124:127], a[84:87], v[108:111]
    ds_read_b128 a[32:35], v16 offset:16384
    v_mfma_f32_16x16x32_bf16 v[164:167], a[128:131], a[84:87], v[164:167]
    ds_read_b128 a[36:39], v16 offset:18432
    v_mfma_f32_16x16x32_bf16 v[220:223], a[84:87], a[132:135], v[220:223]
    s_add_u32 m0, s62, 69632
    s_add_u32 s48, s64, 98304
    buffer_load_dwordx4 v10, s[32:35], s48 offen lds
    v_mfma_f32_16x16x32_bf16 v[112:115], a[124:127], a[88:91], v[112:115]
    ds_read_b128 a[40:43], v16 offset:20480
    v_mfma_f32_16x16x32_bf16 v[168:171], a[128:131], a[88:91], v[168:171]
    ds_read_b128 a[44:47], v16 offset:22528
    s_waitcnt lgkmcnt(10)
    v_mfma_f32_16x16x32_bf16 v[224:227], a[88:91], a[132:135], v[224:227]
    v_mfma_f32_16x16x32_bf16 v[116:119], a[124:127], a[92:95], v[116:119]
    ds_read_b128 a[48:51], v16 offset:24576
    v_mfma_f32_16x16x32_bf16 v[172:175], a[128:131], a[92:95], v[172:175]
    ds_read_b128 a[52:55], v16 offset:26624
    v_mfma_f32_16x16x32_bf16 v[228:231], a[92:95], a[132:135], v[228:231]
    s_add_u32 m0, s62, 73728
    s_add_u32 s48, s64, 131072
    buffer_load_dwordx4 v10, s[32:35], s48 offen lds
    v_mfma_f32_16x16x32_bf16 v[120:123], a[124:127], a[96:99], v[120:123]
    v_mfma_f32_16x16x32_bf16 v[176:179], a[128:131], a[96:99], v[176:179]
    v_mfma_f32_16x16x32_bf16 v[232:235], a[96:99], a[132:135], v[232:235]
    v_mfma_f32_16x16x32_bf16 v[124:127], a[124:127], a[100:103], v[124:127]
    v_mfma_f32_16x16x32_bf16 v[180:183], a[128:131], a[100:103], v[180:183]
    v_mfma_f32_16x16x32_bf16 v[236:239], a[100:103], a[132:135], v[236:239]
    s_add_u32 m0, s62, 77824
    s_add_u32 s48, s64, 163840
    buffer_load_dwordx4 v10, s[32:35], s48 offen lds
    v_mfma_f32_16x16x32_bf16 v[128:131], a[124:127], a[104:107], v[128:131]
    v_mfma_f32_16x16x32_bf16 v[184:187], a[128:131], a[104:107], v[184:187]
    v_mfma_f32_16x16x32_bf16 v[240:243], a[104:107], a[132:135], v[240:243]
    v_mfma_f32_16x16x32_bf16 v[132:135], a[124:127], a[108:111], v[132:135]
    v_mfma_f32_16x16x32_bf16 v[188:191], a[128:131], a[108:111], v[188:191]
    v_mfma_f32_16x16x32_bf16 v[244:247], a[108:111], a[132:135], v[244:247]
    buffer_load_dwordx2 v[36:37], v34, s[44:47], 0 offen sc1
    buffer_load_dwordx2 v[38:39], v32, s[28:31], 0 offen sc1
    v_mfma_f32_16x16x32_bf16 v[72:75], a[112:115], v[28:31], v[72:75]
    s_add_u32 m0, s62, 81920
    s_add_u32 s48, s65, 0
    buffer_load_dwordx4 v11, s[36:39], s48 offen lds
    v_mfma_f32_16x16x32_bf16 v[76:79], a[116:119], v[28:31], v[76:79]
    ds_read_b64_tr_b16 a[124:125], v20 offset:4096
    v_mfma_f32_16x16x32_bf16 v[80:83], v[28:31], a[120:123], v[80:83]
    v_mfma_f32_16x16x32_bf16 v[136:139], a[116:119], a[0:3], v[136:139]
    ds_read_b64_tr_b16 a[126:127], v20 offset:4608
    s_waitcnt lgkmcnt(10)
    v_mfma_f32_16x16x32_bf16 v[192:195], a[0:3], a[120:123], v[192:195]
    ds_read_b64_tr_b16 a[128:129], v20 offset:12288
    v_mfma_f32_16x16x32_bf16 v[84:87], a[112:115], a[4:7], v[84:87]
    v_mfma_f32_16x16x32_bf16 v[140:143], a[116:119], a[4:7], v[140:143]
    ds_read_b64_tr_b16 a[130:131], v20 offset:12800
    v_mfma_f32_16x16x32_bf16 v[196:199], a[4:7], a[120:123], v[196:199]
    ds_read_b64_tr_b16 a[132:133], v20 offset:20480
    s_add_u32 m0, s62, 86016
    s_add_u32 s48, s65, 98304
    buffer_load_dwordx4 v11, s[36:39], s48 offen lds
    v_mfma_f32_16x16x32_bf16 v[88:91], a[112:115], a[8:11], v[88:91]
    v_mfma_f32_16x16x32_bf16 v[144:147], a[116:119], a[8:11], v[144:147]
    ds_read_b64_tr_b16 a[134:135], v20 offset:20992
    s_waitcnt lgkmcnt(10)
    v_mfma_f32_16x16x32_bf16 v[200:203], a[8:11], a[120:123], v[200:203]
    ds_read_b128 a[56:59], v17 offset:0
    v_mfma_f32_16x16x32_bf16 v[92:95], a[112:115], a[12:15], v[92:95]
    v_mfma_f32_16x16x32_bf16 v[148:151], a[116:119], a[12:15], v[148:151]
    ds_read_b128 a[60:63], v17 offset:2048
    v_mfma_f32_16x16x32_bf16 v[204:207], a[12:15], a[120:123], v[204:207]
    ds_read_b128 a[64:67], v17 offset:4096
    v_mfma_f32_16x16x32_bf16 v[96:99], a[112:115], a[16:19], v[96:99]
    s_add_u32 m0, s62, 90112
    s_add_u32 s48, s65, 1024
    buffer_load_dwordx4 v11, s[36:39], s48 offen lds
    v_mfma_f32_16x16x32_bf16 v[152:155], a[116:119], a[16:19], v[152:155]
    ds_read_b128 a[68:71], v17 offset:6144
    s_waitcnt lgkmcnt(10)
    v_mfma_f32_16x16x32_bf16 v[208:211], a[16:19], a[120:123], v[208:211]
    ds_read_b128 a[72:75], v17 offset:8192
    v_mfma_f32_16x16x32_bf16 v[100:103], a[112:115], a[20:23], v[100:103]
    v_mfma_f32_16x16x32_bf16 v[156:159], a[116:119], a[20:23], v[156:159]
    ds_read_b128 a[76:79], v17 offset:10240
    v_mfma_f32_16x16x32_bf16 v[212:215], a[20:23], a[120:123], v[212:215]
    v_mfma_f32_16x16x32_bf16 v[104:107], a[112:115], a[24:27], v[104:107]
    ds_read_b128 a[80:83], v17 offset:12288
    v_mfma_f32_16x16x32_bf16 v[160:163], a[116:119], a[24:27], v[160:163]
    ds_read_b128 a[84:87], v17 offset:14336
    s_waitcnt lgkmcnt(10)
    s_add_u32 m0, s62, 94208
    s_add_u32 s48, s65, 99328
    buffer_load_dwordx4 v11, s[36:39], s48 offen lds
    v_mfma_f32_16x16x32_bf16 v[216:219], a[24:27], a[120:123], v[216:219]
    v_mfma_f32_16x16x32_bf16 v[108:111], a[112:115], a[28:31], v[108:111]
    ds_read_b128 a[88:91], v17 offset:16384
    v_mfma_f32_16x16x32_bf16 v[164:167], a[116:119], a[28:31], v[164:167]
    ds_read_b128 a[92:95], v17 offset:18432
    v_mfma_f32_16x16x32_bf16 v[220:223], a[28:31], a[120:123], v[220:223]
    v_mfma_f32_16x16x32_bf16 v[112:115], a[112:115], a[32:35], v[112:115]
    ds_read_b128 a[96:99], v17 offset:20480
    v_mfma_f32_16x16x32_bf16 v[168:171], a[116:119], a[32:35], v[168:171]
    ds_read_b128 a[100:103], v17 offset:22528
    s_waitcnt lgkmcnt(10)
    v_mfma_f32_16x16x32_bf16 v[224:227], a[32:35], a[120:123], v[224:227]
    v_mfma_f32_16x16x32_bf16 v[116:119], a[112:115], a[36:39], v[116:119]
    ds_read_b128 a[104:107], v17 offset:24576
    s_add_u32 m0, s62, 98304
    s_add_u32 s48, s65, 2048
    buffer_load_dwordx4 v11, s[36:39], s48 offen lds
    v_mfma_f32_16x16x32_bf16 v[172:175], a[116:119], a[36:39], v[172:175]
    ds_read_b128 a[108:111], v17 offset:26624
    v_mfma_f32_16x16x32_bf16 v[228:231], a[36:39], a[120:123], v[228:231]
    v_mfma_f32_16x16x32_bf16 v[120:123], a[112:115], a[40:43], v[120:123]
    v_mfma_f32_16x16x32_bf16 v[176:179], a[116:119], a[40:43], v[176:179]
    v_mfma_f32_16x16x32_bf16 v[232:235], a[40:43], a[120:123], v[232:235]
    v_mfma_f32_16x16x32_bf16 v[124:127], a[112:115], a[44:47], v[124:127]
    v_mfma_f32_16x16x32_bf16 v[180:183], a[116:119], a[44:47], v[180:183]
    s_add_u32 m0, s62, 102400
    s_add_u32 s48, s65, 100352
    buffer_load_dwordx4 v11, s[36:39], s48 offen lds
    v_mfma_f32_16x16x32_bf16 v[236:239], a[44:47], a[120:123], v[236:239]
    v_mfma_f32_16x16x32_bf16 v[128:131], a[112:115], a[48:51], v[128:131]
    v_mfma_f32_16x16x32_bf16 v[184:187], a[116:119], a[48:51], v[184:187]
    v_mfma_f32_16x16x32_bf16 v[240:243], a[48:51], a[120:123], v[240:243]
    v_mfma_f32_16x16x32_bf16 v[132:135], a[112:115], a[52:55], v[132:135]
    v_mfma_f32_16x16x32_bf16 v[188:191], a[116:119], a[52:55], v[188:191]
    v_mfma_f32_16x16x32_bf16 v[244:247], a[52:55], a[120:123], v[244:247]
    s_waitcnt lgkmcnt(0)
    s_waitcnt vmcnt(15)
    s_barrier
    v_mfma_f32_16x16x32_bf16 v[72:75], a[124:127], v[28:31], v[72:75]
    v_mfma_f32_16x16x32_bf16 v[76:79], a[128:131], v[28:31], v[76:79]
    ds_read_b64_tr_b16 a[112:113], v18 offset:0
    v_mfma_f32_16x16x32_bf16 v[80:83], v[28:31], a[132:135], v[80:83]
    v_mfma_f32_16x16x32_bf16 v[136:139], a[128:131], a[56:59], v[136:139]
    ds_read_b64_tr_b16 a[114:115], v18 offset:512
    v_mfma_f32_16x16x32_bf16 v[192:195], a[56:59], a[132:135], v[192:195]
    ds_read_b64_tr_b16 a[116:117], v18 offset:8192
    v_mfma_f32_16x16x32_bf16 v[84:87], a[124:127], a[60:63], v[84:87]
    v_mfma_f32_16x16x32_bf16 v[140:143], a[128:131], a[60:63], v[140:143]
    ds_read_b64_tr_b16 a[118:119], v18 offset:8704
    v_mfma_f32_16x16x32_bf16 v[196:199], a[60:63], a[132:135], v[196:199]
    ds_read_b64_tr_b16 a[120:121], v18 offset:16384
    v_mfma_f32_16x16x32_bf16 v[88:91], a[124:127], a[64:67], v[88:91]
    v_mfma_f32_16x16x32_bf16 v[144:147], a[128:131], a[64:67], v[144:147]
    ds_read_b64_tr_b16 a[122:123], v18 offset:16896
    v_mfma_f32_16x16x32_bf16 v[200:203], a[64:67], a[132:135], v[200:203]
    ds_read_b128 a[0:3], v12 offset:0
    v_mfma_f32_16x16x32_bf16 v[92:95], a[124:127], a[68:71], v[92:95]
    v_mfma_f32_16x16x32_bf16 v[148:151], a[128:131], a[68:71], v[148:151]
    ds_read_b128 a[4:7], v12 offset:2048
    v_mfma_f32_16x16x32_bf16 v[204:207], a[68:71], a[132:135], v[204:207]
    ds_read_b128 a[8:11], v12 offset:4096
    v_mfma_f32_16x16x32_bf16 v[96:99], a[124:127], a[72:75], v[96:99]
    v_mfma_f32_16x16x32_bf16 v[152:155], a[128:131], a[72:75], v[152:155]
    ds_read_b128 a[12:15], v12 offset:6144
    v_mfma_f32_16x16x32_bf16 v[208:211], a[72:75], a[132:135], v[208:211]
    ds_read_b128 a[16:19], v12 offset:8192
    v_mfma_f32_16x16x32_bf16 v[100:103], a[124:127], a[76:79], v[100:103]
    v_mfma_f32_16x16x32_bf16 v[156:159], a[128:131], a[76:79], v[156:159]
    ds_read_b128 a[20:23], v12 offset:10240
    v_mfma_f32_16x16x32_bf16 v[212:215], a[76:79], a[132:135], v[212:215]
    v_mfma_f32_16x16x32_bf16 v[104:107], a[124:127], a[80:83], v[104:107]
    ds_read_b128 a[24:27], v12 offset:12288
    v_mfma_f32_16x16x32_bf16 v[160:163], a[128:131], a[80:83], v[160:163]
    ds_read_b128 a[28:31], v12 offset:14336
    s_waitcnt lgkmcnt(10)
    v_mfma_f32_16x16x32_bf16 v[216:219], a[80:83], a[132:135], v[216:219]
    v_mfma_f32_16x16x32_bf16 v[108:111], a[124:127], a[84:87], v[108:111]
    ds_read_b128 a[32:35], v12 offset:16384
    v_mfma_f32_16x16x32_bf16 v[164:167], a[128:131], a[84:87], v[164:167]
    ds_read_b128 a[36:39], v12 offset:18432
    v_mfma_f32_16x16x32_bf16 v[220:223], a[84:87], a[132:135], v[220:223]
    v_mfma_f32_16x16x32_bf16 v[112:115], a[124:127], a[88:91], v[112:115]
    ds_read_b128 a[40:43], v12 offset:20480
    v_mfma_f32_16x16x32_bf16 v[168:171], a[128:131], a[88:91], v[168:171]
    ds_read_b128 a[44:47], v12 offset:22528
    s_waitcnt lgkmcnt(10)
    v_mfma_f32_16x16x32_bf16 v[224:227], a[88:91], a[132:135], v[224:227]
    v_mfma_f32_16x16x32_bf16 v[116:119], a[124:127], a[92:95], v[116:119]
    ds_read_b128 a[48:51], v12 offset:24576
    v_mfma_f32_16x16x32_bf16 v[172:175], a[128:131], a[92:95], v[172:175]
    ds_read_b128 a[52:55], v12 offset:26624
    v_mfma_f32_16x16x32_bf16 v[228:231], a[92:95], a[132:135], v[228:231]
    v_mfma_f32_16x16x32_bf16 v[120:123], a[124:127], a[96:99], v[120:123]
    v_mfma_f32_16x16x32_bf16 v[176:179], a[128:131], a[96:99], v[176:179]
    v_mfma_f32_16x16x32_bf16 v[232:235], a[96:99], a[132:135], v[232:235]
    v_mfma_f32_16x16x32_bf16 v[124:127], a[124:127], a[100:103], v[124:127]
    v_mfma_f32_16x16x32_bf16 v[180:183], a[128:131], a[100:103], v[180:183]
    v_mfma_f32_16x16x32_bf16 v[236:239], a[100:103], a[132:135], v[236:239]
    v_mfma_f32_16x16x32_bf16 v[128:131], a[124:127], a[104:107], v[128:131]
    v_mfma_f32_16x16x32_bf16 v[184:187], a[128:131], a[104:107], v[184:187]
    v_mfma_f32_16x16x32_bf16 v[240:243], a[104:107], a[132:135], v[240:243]
    v_mfma_f32_16x16x32_bf16 v[132:135], a[124:127], a[108:111], v[132:135]
    v_mfma_f32_16x16x32_bf16 v[188:191], a[128:131], a[108:111], v[188:191]
    v_mfma_f32_16x16x32_bf16 v[244:247], a[108:111], a[132:135], v[244:247]
    s_waitcnt vmcnt(6)
    v_readfirstlane_b32 s74, v36
    v_readfirstlane_b32 s75, v37
    s_or_b32 s49, s74, s75
    s_cmp_eq_u32 s49, 0
    s_cbranch_scc1 Lslow_16
    v_cmp_ne_u32 vcc, s74, v38
    v_cmp_ne_u32 s[50:51], s75, v39
    s_or_b64 vcc, vcc, s[50:51]
    s_cbranch_vccz Lok_15
Lslow_16:
    s_mov_b32 s48, 0
Lnp_17:
    v_mov_b32 v2, 0
    buffer_load_dwordx2 v[4:5], v2, s[44:47], 0 offen sc1
    s_waitcnt vmcnt(0)
    v_readfirstlane_b32 s74, v4
    v_readfirstlane_b32 s75, v5
    s_add_u32 s48, s48, 1
    s_or_b32 s49, s74, s75
    s_cmp_lg_u32 s49, 0
    s_cbranch_scc1 Lnd_18
    s_cmp_lt_u32 s48, 200000
    s_cbranch_scc1 Lnp_17
Lnd_18:
    s_mov_b32 s48, 0
Lp_19:
    buffer_load_dwordx2 v[4:5], v32, s[28:31], 0 offen sc1
    s_add_u32 s48, s48, 1
    s_waitcnt vmcnt(0)
    v_cmp_ne_u32 vcc, s74, v4
    v_cmp_ne_u32 s[50:51], s75, v5
    s_or_b64 vcc, vcc, s[50:51]
    s_cbranch_vccz Ld_20
    s_cmp_lt_u32 s48, 200000
    s_cbranch_scc0 Ld_20
    s_sleep 1
    s_branch Lp_19
Ld_20:
Lok_15:
    s_mov_b32 s48, 0x600000
    buffer_load_dword v40, v33, s[28:31], s48 offen sc1
    s_mov_b32 s48, 0x602000
    buffer_load_dword v41, v33, s[28:31], s48 offen sc1
    v_mfma_f32_16x16x32_bf16 v[72:75], a[112:115], v[28:31], v[72:75]
    v_mfma_f32_16x16x32_bf16 v[76:79], a[116:119], v[28:31], v[76:79]
    ds_read_b64_tr_b16 a[124:125], v18 offset:4096
    v_mfma_f32_16x16x32_bf16 v[80:83], v[28:31], a[120:123], v[80:83]
    v_mfma_f32_16x16x32_bf16 v[136:139], a[116:119], a[0:3], v[136:139]
    ds_read_b64_tr_b16 a[126:127], v18 offset:4608
    s_waitcnt lgkmcnt(10)
    v_mfma_f32_16x16x32_bf16 v[192:195], a[0:3], a[120:123], v[192:195]
    ds_read_b64_tr_b16 a[128:129], v18 offset:12288
    v_mfma_f32_16x16x32_bf16 v[84:87], a[112:115], a[4:7], v[84:87]
    v_mfma_f32_16x16x32_bf16 v[140:143], a[116:119], a[4:7], v[140:143]
    ds_read_b64_tr_b16 a[130:131], v18 offset:12800
    v_mfma_f32_16x16x32_bf16 v[196:199], a[4:7], a[120:123], v[196:199]
    ds_read_b64_tr_b16 a[132:133], v18 offset:20480
    v_mfma_f32_16x16x32_bf16 v[88:91], a[112:115], a[8:11], v[88:91]
    v_mfma_f32_16x16x32_bf16 v[144:147], a[116:119], a[8:11], v[144:147]
    ds_read_b64_tr_b16 a[134:135], v18 offset:20992
    s_waitcnt lgkmcnt(10)
    v_mfma_f32_16x16x32_bf16 v[200:203], a[8:11], a[120:123], v[200:203]
    ds_read_b128 a[56:59], v13 offset:0
    v_mfma_f32_16x16x32_bf16 v[92:95], a[112:115], a[12:15], v[92:95]
    v_mfma_f32_16x16x32_bf16 v[148:151], a[116:119], a[12:15], v[148:151]
    ds_read_b128 a[60:63], v13 offset:2048
    v_mfma_f32_16x16x32_bf16 v[204:207], a[12:15], a[120:123], v[204:207]
    ds_read_b128 a[64:67], v13 offset:4096
    v_mfma_f32_16x16x32_bf16 v[96:99], a[112:115], a[16:19], v[96:99]
    v_mfma_f32_16x16x32_bf16 v[152:155], a[116:119], a[16:19], v[152:155]
    ds_read_b128 a[68:71], v13 offset:6144
    s_waitcnt lgkmcnt(10)
    v_mfma_f32_16x16x32_bf16 v[208:211], a[16:19], a[120:123], v[208:211]
    ds_read_b128 a[72:75], v13 offset:8192
    v_mfma_f32_16x16x32_bf16 v[100:103], a[112:115], a[20:23], v[100:103]
    v_mfma_f32_16x16x32_bf16 v[156:159], a[116:119], a[20:23], v[156:159]
    ds_read_b128 a[76:79], v13 offset:10240
    v_mfma_f32_16x16x32_bf16 v[212:215], a[20:23], a[120:123], v[212:215]
    v_mfma_f32_16x16x32_bf16 v[104:107], a[112:115], a[24:27], v[104:107]
    ds_read_b128 a[80:83], v13 offset:12288
    v_mfma_f32_16x16x32_bf16 v[160:163], a[116:119], a[24:27], v[160:163]
    ds_read_b128 a[84:87], v13 offset:14336
    s_waitcnt lgkmcnt(10)
    v_mfma_f32_16x16x32_bf16 v[216:219], a[24:27], a[120:123], v[216:219]
    v_mfma_f32_16x16x32_bf16 v[108:111], a[112:115], a[28:31], v[108:111]
    ds_read_b128 a[88:91], v13 offset:16384
    v_mfma_f32_16x16x32_bf16 v[164:167], a[116:119], a[28:31], v[164:167]
    ds_read_b128 a[92:95], v13 offset:18432
    v_mfma_f32_16x16x32_bf16 v[220:223], a[28:31], a[120:123], v[220:223]
    v_mfma_f32_16x16x32_bf16 v[112:115], a[112:115], a[32:35], v[112:115]
    ds_read_b128 a[96:99], v13 offset:20480
    v_mfma_f32_16x16x32_bf16 v[168:171], a[116:119], a[32:35], v[168:171]
    ds_read_b128 a[100:103], v13 offset:22528
    s_waitcnt lgkmcnt(10)
    v_mfma_f32_16x16x32_bf16 v[224:227], a[32:35], a[120:123], v[224:227]
    v_mfma_f32_16x16x32_bf16 v[116:119], a[112:115], a[36:39], v[116:119]
    ds_read_b128 a[104:107], v13 offset:24576
    v_mfma_f32_16x16x32_bf16 v[172:175], a[116:119], a[36:39], v[172:175]
    ds_read_b128 a[108:111], v13 offset:26624
    v_mfma_f32_16x16x32_bf16 v[228:231], a[36:39], a[120:123], v[228:231]
    v_mfma_f32_16x16x32_bf16 v[120:123], a[112:115], a[40:43], v[120:123]
    v_mfma_f32_16x16x32_bf16 v[176:179], a[116:119], a[40:43], v[176:179]
    v_mfma_f32_16x16x32_bf16 v[232:235], a[40:43], a[120:123], v[232:235]
    v_mfma_f32_16x16x32_bf16 v[124:127], a[112:115], a[44:47], v[124:127]
    v_mfma_f32_16x16x32_bf16 v[180:183], a[116:119], a[44:47], v[180:183]
    v_mfma_f32_16x16x32_bf16 v[236:239], a[44:47], a[120:123], v[236:239]
    v_mfma_f32_16x16x32_bf16 v[128:131], a[112:115], a[48:51], v[128:131]
    v_mfma_f32_16x16x32_bf16 v[184:187], a[116:119], a[48:51], v[184:187]
    v_mfma_f32_16x16x32_bf16 v[240:243], a[48:51], a[120:123], v[240:243]
    v_mfma_f32_16x16x32_bf16 v[132:135], a[112:115], a[52:55], v[132:135]
    v_mfma_f32_16x16x32_bf16 v[188:191], a[116:119], a[52:55], v[188:191]
    v_mfma_f32_16x16x32_bf16 v[244:247], a[52:55], a[120:123], v[244:247]
    s_waitcnt lgkmcnt(0)
    s_waitcnt vmcnt(2)
    s_barrier
    v_mfma_f32_16x16x32_bf16 v[72:75], a[124:127], v[28:31], v[72:75]
    v_mfma_f32_16x16x32_bf16 v[76:79], a[128:131], v[28:31], v[76:79]
    ds_read_b64_tr_b16 a[112:113], v19 offset:0
    v_mfma_f32_16x16x32_bf16 v[80:83], v[28:31], a[132:135], v[80:83]
    v_mfma_f32_16x16x32_bf16 v[136:139], a[128:131], a[56:59], v[136:139]
    ds_read_b64_tr_b16 a[114:115], v19 offset:512
    v_mfma_f32_16x16x32_bf16 v[192:195], a[56:59], a[132:135], v[192:195]
    ds_read_b64_tr_b16 a[116:117], v19 offset:8192
    v_mfma_f32_16x16x32_bf16 v[84:87], a[124:127], a[60:63], v[84:87]
    v_mfma_f32_16x16x32_bf16 v[140:143], a[128:131], a[60:63], v[140:143]
    ds_read_b64_tr_b16 a[118:119], v19 offset:8704
    v_mfma_f32_16x16x32_bf16 v[196:199], a[60:63], a[132:135], v[196:199]
    ds_read_b64_tr_b16 a[120:121], v19 offset:16384
    v_mfma_f32_16x16x32_bf16 v[88:91], a[124:127], a[64:67], v[88:91]
    v_mfma_f32_16x16x32_bf16 v[144:147], a[128:131], a[64:67], v[144:147]
    ds_read_b64_tr_b16 a[122:123], v19 offset:16896
    v_mfma_f32_16x16x32_bf16 v[200:203], a[64:67], a[132:135], v[200:203]
    ds_read_b128 a[0:3], v14 offset:0
    v_mfma_f32_16x16x32_bf16 v[92:95], a[124:127], a[68:71], v[92:95]
    v_mfma_f32_16x16x32_bf16 v[148:151], a[128:131], a[68:71], v[148:151]
    ds_read_b128 a[4:7], v14 offset:2048
    v_mfma_f32_16x16x32_bf16 v[204:207], a[68:71], a[132:135], v[204:207]
    ds_read_b128 a[8:11], v14 offset:4096
    v_mfma_f32_16x16x32_bf16 v[96:99], a[124:127], a[72:75], v[96:99]
    v_mfma_f32_16x16x32_bf16 v[152:155], a[128:131], a[72:75], v[152:155]
    ds_read_b128 a[12:15], v14 offset:6144
    v_mfma_f32_16x16x32_bf16 v[208:211], a[72:75], a[132:135], v[208:211]
    ds_read_b128 a[16:19], v14 offset:8192
    v_mfma_f32_16x16x32_bf16 v[100:103], a[124:127], a[76:79], v[100:103]
    v_mfma_f32_16x16x32_bf16 v[156:159], a[128:131], a[76:79], v[156:159]
    ds_read_b128 a[20:23], v14 offset:10240
    v_mfma_f32_16x16x32_bf16 v[212:215], a[76:79], a[132:135], v[212:215]
    v_mfma_f32_16x16x32_bf16 v[104:107], a[124:127], a[80:83], v[104:107]
    ds_read_b128 a[24:27], v14 offset:12288
    v_mfma_f32_16x16x32_bf16 v[160:163], a[128:131], a[80:83], v[160:163]
    ds_read_b128 a[28:31], v14 offset:14336
    s_waitcnt lgkmcnt(10)
    v_mfma_f32_16x16x32_bf16 v[216:219], a[80:83], a[132:135], v[216:219]
    v_mfma_f32_16x16x32_bf16 v[108:111], a[124:127], a[84:87], v[108:111]
    ds_read_b128 a[32:35], v14 offset:16384
    v_mfma_f32_16x16x32_bf16 v[164:167], a[128:131], a[84:87], v[164:167]
    ds_read_b128 a[36:39], v14 offset:18432
    v_mfma_f32_16x16x32_bf16 v[220:223], a[84:87], a[132:135], v[220:223]
    v_mfma_f32_16x16x32_bf16 v[112:115], a[124:127], a[88:91], v[112:115]
    ds_read_b128 a[40:43], v14 offset:20480
    v_mfma_f32_16x16x32_bf16 v[168:171], a[128:131], a[88:91], v[168:171]
    ds_read_b128 a[44:47], v14 offset:22528
    s_waitcnt lgkmcnt(10)
    v_mfma_f32_16x16x32_bf16 v[224:227], a[88:91], a[132:135], v[224:227]
    v_mfma_f32_16x16x32_bf16 v[116:119], a[124:127], a[92:95], v[116:119]
    ds_read_b128 a[48:51], v14 offset:24576
    v_mfma_f32_16x16x32_bf16 v[172:175], a[128:131], a[92:95], v[172:175]
    ds_read_b128 a[52:55], v14 offset:26624
    v_mfma_f32_16x16x32_bf16 v[228:231], a[92:95], a[132:135], v[228:231]
    v_mfma_f32_16x16x32_bf16 v[120:123], a[124:127], a[96:99], v[120:123]
    v_mfma_f32_16x16x32_bf16 v[176:179], a[128:131], a[96:99], v[176:179]
    v_mfma_f32_16x16x32_bf16 v[232:235], a[96:99], a[132:135], v[232:235]
    v_mfma_f32_16x16x32_bf16 v[124:127], a[124:127], a[100:103], v[124:127]
    v_mfma_f32_16x16x32_bf16 v[180:183], a[128:131], a[100:103], v[180:183]
    v_mfma_f32_16x16x32_bf16 v[236:239], a[100:103], a[132:135], v[236:239]
    v_mfma_f32_16x16x32_bf16 v[128:131], a[124:127], a[104:107], v[128:131]
    v_mfma_f32_16x16x32_bf16 v[184:187], a[128:131], a[104:107], v[184:187]
    v_mfma_f32_16x16x32_bf16 v[240:243], a[104:107], a[132:135], v[240:243]
    v_mfma_f32_16x16x32_bf16 v[132:135], a[124:127], a[108:111], v[132:135]
    v_mfma_f32_16x16x32_bf16 v[188:191], a[128:131], a[108:111], v[188:191]
    v_mfma_f32_16x16x32_bf16 v[244:247], a[108:111], a[132:135], v[244:247]
    v_mfma_f32_16x16x32_bf16 v[72:75], a[112:115], v[28:31], v[72:75]
    v_mfma_f32_16x16x32_bf16 v[76:79], a[116:119], v[28:31], v[76:79]
    ds_read_b64_tr_b16 a[124:125], v19 offset:4096
    v_mfma_f32_16x16x32_bf16 v[80:83], v[28:31], a[120:123], v[80:83]
    v_mfma_f32_16x16x32_bf16 v[136:139], a[116:119], a[0:3], v[136:139]
    ds_read_b64_tr_b16 a[126:127], v19 offset:4608
    s_waitcnt lgkmcnt(10)
    v_mfma_f32_16x16x32_bf16 v[192:195], a[0:3], a[120:123], v[192:195]
    ds_read_b64_tr_b16 a[128:129], v19 offset:12288
    v_mfma_f32_16x16x32_bf16 v[84:87], a[112:115], a[4:7], v[84:87]
    v_mfma_f32_16x16x32_bf16 v[140:143], a[116:119], a[4:7], v[140:143]
    ds_read_b64_tr_b16 a[130:131], v19 offset:12800
    v_mfma_f32_16x16x32_bf16 v[196:199], a[4:7], a[120:123], v[196:199]
    ds_read_b64_tr_b16 a[132:133], v19 offset:20480
    v_mfma_f32_16x16x32_bf16 v[88:91], a[112:115], a[8:11], v[88:91]
    v_mfma_f32_16x16x32_bf16 v[144:147], a[116:119], a[8:11], v[144:147]
    ds_read_b64_tr_b16 a[134:135], v19 offset:20992
    s_waitcnt lgkmcnt(10)
    v_mfma_f32_16x16x32_bf16 v[200:203], a[8:11], a[120:123], v[200:203]
    ds_read_b128 a[56:59], v15 offset:0
    v_mfma_f32_16x16x32_bf16 v[92:95], a[112:115], a[12:15], v[92:95]
    v_mfma_f32_16x16x32_bf16 v[148:151], a[116:119], a[12:15], v[148:151]
    ds_read_b128 a[60:63], v15 offset:2048
    v_mfma_f32_16x16x32_bf16 v[204:207], a[12:15], a[120:123], v[204:207]
    ds_read_b128 a[64:67], v15 offset:4096
    v_mfma_f32_16x16x32_bf16 v[96:99], a[112:115], a[16:19], v[96:99]
    v_mfma_f32_16x16x32_bf16 v[152:155], a[116:119], a[16:19], v[152:155]
    ds_read_b128 a[68:71], v15 offset:6144
    s_waitcnt lgkmcnt(10)
    v_mfma_f32_16x16x32_bf16 v[208:211], a[16:19], a[120:123], v[208:211]
    ds_read_b128 a[72:75], v15 offset:8192
    v_mfma_f32_16x16x32_bf16 v[100:103], a[112:115], a[20:23], v[100:103]
    v_mfma_f32_16x16x32_bf16 v[156:159], a[116:119], a[20:23], v[156:159]
    ds_read_b128 a[76:79], v15 offset:10240
    v_mfma_f32_16x16x32_bf16 v[212:215], a[20:23], a[120:123], v[212:215]
    v_mfma_f32_16x16x32_bf16 v[104:107], a[112:115], a[24:27], v[104:107]
    ds_read_b128 a[80:83], v15 offset:12288
    v_mfma_f32_16x16x32_bf16 v[160:163], a[116:119], a[24:27], v[160:163]
    ds_read_b128 a[84:87], v15 offset:14336
    s_waitcnt lgkmcnt(10)
    v_mfma_f32_16x16x32_bf16 v[216:219], a[24:27], a[120:123], v[216:219]
    v_mfma_f32_16x16x32_bf16 v[108:111], a[112:115], a[28:31], v[108:111]
    ds_read_b128 a[88:91], v15 offset:16384
    v_mfma_f32_16x16x32_bf16 v[164:167], a[116:119], a[28:31], v[164:167]
    ds_read_b128 a[92:95], v15 offset:18432
    v_mfma_f32_16x16x32_bf16 v[220:223], a[28:31], a[120:123], v[220:223]
    v_mfma_f32_16x16x32_bf16 v[112:115], a[112:115], a[32:35], v[112:115]
    ds_read_b128 a[96:99], v15 offset:20480
    v_mfma_f32_16x16x32_bf16 v[168:171], a[116:119], a[32:35], v[168:171]
    ds_read_b128 a[100:103], v15 offset:22528
    s_waitcnt lgkmcnt(10)
    v_mfma_f32_16x16x32_bf16 v[224:227], a[32:35], a[120:123], v[224:227]
    v_mfma_f32_16x16x32_bf16 v[116:119], a[112:115], a[36:39], v[116:119]
    ds_read_b128 a[104:107], v15 offset:24576
    v_mfma_f32_16x16x32_bf16 v[172:175], a[116:119], a[36:39], v[172:175]
    ds_read_b128 a[108:111], v15 offset:26624
    v_mfma_f32_16x16x32_bf16 v[228:231], a[36:39], a[120:123], v[228:231]
    v_mfma_f32_16x16x32_bf16 v[120:123], a[112:115], a[40:43], v[120:123]
    v_mfma_f32_16x16x32_bf16 v[176:179], a[116:119], a[40:43], v[176:179]
    v_mfma_f32_16x16x32_bf16 v[232:235], a[40:43], a[120:123], v[232:235]
    v_mfma_f32_16x16x32_bf16 v[124:127], a[112:115], a[44:47], v[124:127]
    v_mfma_f32_16x16x32_bf16 v[180:183], a[116:119], a[44:47], v[180:183]
    v_mfma_f32_16x16x32_bf16 v[236:239], a[44:47], a[120:123], v[236:239]
    v_mfma_f32_16x16x32_bf16 v[128:131], a[112:115], a[48:51], v[128:131]
    v_mfma_f32_16x16x32_bf16 v[184:187], a[116:119], a[48:51], v[184:187]
    v_mfma_f32_16x16x32_bf16 v[240:243], a[48:51], a[120:123], v[240:243]
    v_mfma_f32_16x16x32_bf16 v[132:135], a[112:115], a[52:55], v[132:135]
    v_mfma_f32_16x16x32_bf16 v[188:191], a[116:119], a[52:55], v[188:191]
    v_mfma_f32_16x16x32_bf16 v[244:247], a[52:55], a[120:123], v[244:247]
    s_waitcnt lgkmcnt(0)
    v_mfma_f32_16x16x32_bf16 v[72:75], a[124:127], v[28:31], v[72:75]
    v_mfma_f32_16x16x32_bf16 v[76:79], a[128:131], v[28:31], v[76:79]
    v_mfma_f32_16x16x32_bf16 v[80:83], v[28:31], a[132:135], v[80:83]
    v_mfma_f32_16x16x32_bf16 v[136:139], a[128:131], a[56:59], v[136:139]
    v_mfma_f32_16x16x32_bf16 v[192:195], a[56:59], a[132:135], v[192:195]
    v_mfma_f32_16x16x32_bf16 v[84:87], a[124:127], a[60:63], v[84:87]
    v_mfma_f32_16x16x32_bf16 v[140:143], a[128:131], a[60:63], v[140:143]
    v_mfma_f32_16x16x32_bf16 v[196:199], a[60:63], a[132:135], v[196:199]
    v_mfma_f32_16x16x32_bf16 v[88:91], a[124:127], a[64:67], v[88:91]
    v_mfma_f32_16x16x32_bf16 v[144:147], a[128:131], a[64:67], v[144:147]
    v_mfma_f32_16x16x32_bf16 v[200:203], a[64:67], a[132:135], v[200:203]
    v_mfma_f32_16x16x32_bf16 v[92:95], a[124:127], a[68:71], v[92:95]
    v_mfma_f32_16x16x32_bf16 v[148:151], a[128:131], a[68:71], v[148:151]
    v_mfma_f32_16x16x32_bf16 v[204:207], a[68:71], a[132:135], v[204:207]
    v_mfma_f32_16x16x32_bf16 v[96:99], a[124:127], a[72:75], v[96:99]
    v_mfma_f32_16x16x32_bf16 v[152:155], a[128:131], a[72:75], v[152:155]
    v_mfma_f32_16x16x32_bf16 v[208:211], a[72:75], a[132:135], v[208:211]
    v_mfma_f32_16x16x32_bf16 v[100:103], a[124:127], a[76:79], v[100:103]
    v_mfma_f32_16x16x32_bf16 v[156:159], a[128:131], a[76:79], v[156:159]
    v_mfma_f32_16x16x32_bf16 v[212:215], a[76:79], a[132:135], v[212:215]
    v_mfma_f32_16x16x32_bf16 v[104:107], a[124:127], a[80:83], v[104:107]
    v_mfma_f32_16x16x32_bf16 v[160:163], a[128:131], a[80:83], v[160:163]
    v_mfma_f32_16x16x32_bf16 v[216:219], a[80:83], a[132:135], v[216:219]
    v_mfma_f32_16x16x32_bf16 v[108:111], a[124:127], a[84:87], v[108:111]
    v_mfma_f32_16x16x32_bf16 v[164:167], a[128:131], a[84:87], v[164:167]
    v_mfma_f32_16x16x32_bf16 v[220:223], a[84:87], a[132:135], v[220:223]
    v_mfma_f32_16x16x32_bf16 v[112:115], a[124:127], a[88:91], v[112:115]
    v_mfma_f32_16x16x32_bf16 v[168:171], a[128:131], a[88:91], v[168:171]
    v_mfma_f32_16x16x32_bf16 v[224:227], a[88:91], a[132:135], v[224:227]
    v_mfma_f32_16x16x32_bf16 v[116:119], a[124:127], a[92:95], v[116:119]
    v_mfma_f32_16x16x32_bf16 v[172:175], a[128:131], a[92:95], v[172:175]
    v_mfma_f32_16x16x32_bf16 v[228:231], a[92:95], a[132:135], v[228:231]
    v_mfma_f32_16x16x32_bf16 v[120:123], a[124:127], a[96:99], v[120:123]
    v_mfma_f32_16x16x32_bf16 v[176:179], a[128:131], a[96:99], v[176:179]
    v_mfma_f32_16x16x32_bf16 v[232:235], a[96:99], a[132:135], v[232:235]
    v_mfma_f32_16x16x32_bf16 v[124:127], a[124:127], a[100:103], v[124:127]
    v_mfma_f32_16x16x32_bf16 v[180:183], a[128:131], a[100:103], v[180:183]
    v_mfma_f32_16x16x32_bf16 v[236:239], a[100:103], a[132:135], v[236:239]
    v_mfma_f32_16x16x32_bf16 v[128:131], a[124:127], a[104:107], v[128:131]
    v_mfma_f32_16x16x32_bf16 v[184:187], a[128:131], a[104:107], v[184:187]
    v_mfma_f32_16x16x32_bf16 v[240:243], a[104:107], a[132:135], v[240:243]
    v_mfma_f32_16x16x32_bf16 v[132:135], a[124:127], a[108:111], v[132:135]
    v_mfma_f32_16x16x32_bf16 v[188:191], a[128:131], a[108:111], v[188:191]
    v_mfma_f32_16x16x32_bf16 v[244:247], a[108:111], a[132:135], v[244:247]
    s_waitcnt vmcnt(0)
    s_lshl_b32 s48, s26, 8
    s_add_u32 s48, s48, 159744
    v_lshl_add_u32 v4, v1, 2, s48
    ds_write_b32 v4, v40
    ds_write_b32 v4, v41 offset:1024
    s_waitcnt lgkmcnt(0)
    s_barrier
    s_mov_b32 s32, s8
    s_and_b32 s33, s9, 0xffff
    s_mov_b32 s34, 0x80000
    s_mov_b32 s35, 0x20000
    s_mov_b32 s36, s16
    s_and_b32 s37, s17, 0xffff
    s_mov_b32 s38, 0x560000
    s_mov_b32 s39, 0x20000
    s_lshr_b32 s56, s26, 1
    s_and_b32 s57, s26, 1
    s_mul_i32 s58, s26, 24576
    v_lshrrev_b32 v2, 3, v1
    v_and_b32 v3, 7, v1
    v_bfe_u32 v4, v1, 4, 1
    v_lshlrev_b32 v4, 2, v4
    v_xor_b32 v3, v3, v4
    s_mov_b32 s48, 1024
    v_mul_lo_u32 v2, v2, s48
    v_lshl_add_u32 v10, v3, 4, v2
    v_lshrrev_b32 v2, 3, v1
    v_and_b32 v3, 7, v1
    v_bfe_u32 v4, v1, 4, 1
    v_lshlrev_b32 v4, 2, v4
    v_xor_b32 v3, v3, v4
    s_mov_b32 s48, 4096
    v_mul_lo_u32 v2, v2, s48
    v_lshl_add_u32 v9, v3, 4, v2
    v_lshlrev_b32 v11, 4, v1
    v_bfe_u32 v2, v1, 2, 2
    v_lshrrev_b32 v3, 5, v1
    v_bfe_u32 v4, v1, 4, 1
    v_and_b32 v5, 3, v1
    v_lshl_add_u32 v6, v3, 3, v2
    v_lshlrev_b32 v6, 7, v6
    v_lshrrev_b32 v7, 1, v2
    v_xor_b32 v7, s56, v7
    v_lshl_add_u32 v6, v7, 6, v6
    v_lshl_add_u32 v6, v4, 5, v6
    v_lshrrev_b32 v7, 1, v5
    v_lshl_add_u32 v6, v7, 4, v6
    v_and_b32 v7, 1, v5
    v_lshl_add_u32 v6, v7, 3, v6
    v_add_u32 v12, s58, v6
    v_xor_b32 v13, 64, v12
    v_bfe_u32 v2, v1, 2, 2
    v_lshrrev_b32 v3, 5, v1
    v_bfe_u32 v4, v1, 4, 1
    v_and_b32 v5, 3, v1
    v_lshl_add_u32 v6, v3, 2, v2
    v_lshlrev_b32 v6, 7, v6
    v_lshrrev_b32 v7, 1, v2
    v_xor_b32 v7, s57, v7
    v_lshl_add_u32 v6, v7, 6, v6
    v_lshl_add_u32 v6, v4, 5, v6
    v_lshrrev_b32 v7, 1, v5
    v_lshl_add_u32 v6, v7, 4, v6
    v_and_b32 v7, 1, v5
    v_lshl_add_u32 v6, v7, 3, v6
    v_add_u32 v18, s58, v6
    v_xor_b32 v19, 64, v18
    s_lshl_b32 s60, s79, 7
    s_mul_i32 s48, s26, 131072
    s_add_u32 s60, s60, s48
    s_lshl_b32 s66, s78, 7
    s_mul_i32 s48, s26, 1441792
    s_add_u32 s66, s66, s48
    s_lshl_b32 s62, s78, 1
    s_add_u32 s62, s62, s57
    s_xor_b32 s63, s62, 1
    s_lshl_b32 s62, s62, 15
    s_lshl_b32 s63, s63, 15
    s_lshl_b32 s48, s26, 13
    s_add_u32 s48, s48, 0x400000
    s_add_u32 s62, s62, s48
    s_add_u32 s63, s63, s48
    s_lshl_b32 s68, s79, 1
    s_add_u32 s68, s68, s56
    s_xor_b32 s69, s68, 1
    s_mul_i32 s68, s68, 90112
    s_mul_i32 s69, s69, 90112
    s_mul_i32 s48, s26, 22528
    s_add_u32 s48, s48, 0x200000
    s_add_u32 s68, s68, s48
    s_add_u32 s69, s69, s48
    s_and_b32 s48, s78, 7
    s_and_b32 s49, s79, 3
    s_mul_i32 s64, s49, 5
    s_mul_i32 s65, s48, 3
    s_add_u32 s64, s64, s65
    s_sub_u32 s65, s64, 22
    s_cmp_ge_u32 s64, 22
    s_cselect_b32 s64, s65, s64
    s_lshl_b32 s65, s49, 1
    s_add_u32 s65, s65, s48
    s_lshl_b32 s67, s64, 16
    s_add_u32 s67, s67, s66
    s_add_u32 s61, s66, 1441792
    v_add_u32 v27, 32768, v9
    s_add_u32 m0, s58, 0
    s_add_u32 s48, s67, 65536
    buffer_load_dwordx4 v9, s[36:39], s67 offen lds
    s_add_u32 m0, s58, 1024
    s_cmp_eq_u32 s48, s61
    buffer_load_dwordx4 v27, s[36:39], s67 offen lds
    s_cselect_b32 s67, s66, s48
    s_add_u32 m0, s58, 2048
    s_add_u32 s48, s67, 65536
    buffer_load_dwordx4 v9, s[36:39], s67 offen lds
    s_add_u32 m0, s58, 3072
    s_cmp_eq_u32 s48, s61
    buffer_load_dwordx4 v27, s[36:39], s67 offen lds
    s_cselect_b32 s67, s66, s48
    s_add_u32 m0, s58, 4096
    s_add_u32 s48, s67, 65536
    buffer_load_dwordx4 v9, s[36:39], s67 offen lds
    s_add_u32 m0, s58, 5120
    s_cmp_eq_u32 s48, s61
    buffer_load_dwordx4 v27, s[36:39], s67 offen lds
    s_cselect_b32 s67, s66, s48
    s_add_u32 m0, s58, 6144
    s_add_u32 s48, s67, 65536
    buffer_load_dwordx4 v9, s[36:39], s67 offen lds
    s_add_u32 m0, s58, 7168
    s_cmp_eq_u32 s48, s61
    buffer_load_dwordx4 v27, s[36:39], s67 offen lds
    s_cselect_b32 s67, s66, s48
    s_add_u32 m0, s58, 8192
    s_add_u32 s48, s67, 65536
    buffer_load_dwordx4 v9, s[36:39], s67 offen lds
    s_add_u32 m0, s58, 9216
    s_cmp_eq_u32 s48, s61
    buffer_load_dwordx4 v27, s[36:39], s67 offen lds
    s_cselect_b32 s67, s66, s48
    s_add_u32 m0, s58, 10240
    s_add_u32 s48, s67, 65536
    buffer_load_dwordx4 v9, s[36:39], s67 offen lds
    s_add_u32 m0, s58, 11264
    s_cmp_eq_u32 s48, s61
    buffer_load_dwordx4 v27, s[36:39], s67 offen lds
    s_cselect_b32 s67, s66, s48
    v_and_b32 v4, 15, v1
    v_lshlrev_b32 v4, 2, v4
    v_add_u32 v4, 159744, v4
    v_lshrrev_b32 v5, 4, v1
    v_lshlrev_b32 v5, 4, v5
    v_add_u32 v5, 159744, v5
    ds_read_b32 v32, v4 offset:0
    ds_read_b32 v46, v4 offset:1024
    ds_read_b32 v33, v4 offset:64
    ds_read_b32 v47, v4 offset:1088
    ds_read_b32 v34, v4 offset:128
    ds_read_b32 v48, v4 offset:1152
    ds_read_b32 v35, v4 offset:192
    ds_read_b32 v49, v4 offset:1216
    ds_read_b32 v36, v4 offset:256
    ds_read_b32 v50, v4 offset:1280
    ds_read_b32 v37, v4 offset:320
    ds_read_b32 v51, v4 offset:1344
    ds_read_b32 v38, v4 offset:384
    ds_read_b32 v52, v4 offset:1408
    s_waitcnt lgkmcnt(10)
    ds_read_b32 v39, v4 offset:448
    ds_read_b32 v53, v4 offset:1472
    ds_read_b32 v40, v4 offset:512
    ds_read_b32 v54, v4 offset:1536
    s_waitcnt lgkmcnt(10)
    ds_read_b32 v41, v4 offset:576
    ds_read_b32 v55, v4 offset:1600
    ds_read_b32 v42, v4 offset:640
    ds_read_b32 v56, v4 offset:1664
    s_waitcnt lgkmcnt(10)
    ds_read_b32 v43, v4 offset:704
    ds_read_b32 v57, v4 offset:1728
    ds_read_b32 v44, v4 offset:768
    ds_read_b32 v58, v4 offset:1792
    s_waitcnt lgkmcnt(10)
    ds_read_b32 v45, v4 offset:832
    ds_read_b32 v59, v4 offset:1856
    ds_read_b128 v[60:63], v5 offset:0
    ds_read_b128 v[64:67], v5 offset:1024
    s_waitcnt lgkmcnt(10)
    ds_read_b128 v[248:251], v5 offset:64
    ds_read_b128 v[252:255], v5 offset:1088
    v_pk_fma_f32 v[136:137], v[32:33], v[76:77], v[136:137] op_sel:[0,0,0] op_sel_hi:[0,1,1]
    v_pk_fma_f32 v[138:139], v[32:33], v[78:79], v[138:139] op_sel:[0,0,0] op_sel_hi:[0,1,1]
    v_pk_mul_f32 v[136:137], v[136:137], v[46:47] op_sel:[0,0] op_sel_hi:[1,0]
    v_pk_mul_f32 v[138:139], v[138:139], v[46:47] op_sel:[0,0] op_sel_hi:[1,0]
    s_waitcnt lgkmcnt(2)
    v_pk_fma_f32 v[192:193], v[60:61], v[80:81], v[192:193] op_sel_hi:[1,0,1]
    v_pk_fma_f32 v[194:195], v[62:63], v[80:81], v[194:195] op_sel_hi:[1,0,1]
    v_pk_mul_f32 v[192:193], v[192:193], v[64:65]
    v_pk_mul_f32 v[194:195], v[194:195], v[66:67]
    v_cvt_pk_bf16_f32 v136, v136, v137
    v_cvt_pk_bf16_f32 v137, v138, v139
    v_cvt_pk_bf16_f32 v192, v192, v193
    v_cvt_pk_bf16_f32 v193, v194, v195
    ds_read_b128 v[60:63], v5 offset:128
    ds_read_b128 v[64:67], v5 offset:1152
    v_pk_fma_f32 v[140:141], v[32:33], v[76:77], v[140:141] op_sel:[1,0,0] op_sel_hi:[1,1,1]
    v_pk_fma_f32 v[142:143], v[32:33], v[78:79], v[142:143] op_sel:[1,0,0] op_sel_hi:[1,1,1]
    v_pk_fma_f32 v[84:85], v[32:33], v[72:73], v[84:85] op_sel:[1,0,0] op_sel_hi:[1,1,1]
    v_pk_fma_f32 v[86:87], v[32:33], v[74:75], v[86:87] op_sel:[1,0,0] op_sel_hi:[1,1,1]
    v_pk_mul_f32 v[140:141], v[140:141], v[46:47] op_sel:[0,1] op_sel_hi:[1,1]
    v_pk_mul_f32 v[142:143], v[142:143], v[46:47] op_sel:[0,1] op_sel_hi:[1,1]
    s_waitcnt lgkmcnt(2)
    v_pk_fma_f32 v[196:197], v[248:249], v[80:81], v[196:197] op_sel_hi:[1,0,1]
    v_pk_fma_f32 v[198:199], v[250:251], v[80:81], v[198:199] op_sel_hi:[1,0,1]
    v_pk_mul_f32 v[196:197], v[196:197], v[252:253]
    v_pk_mul_f32 v[198:199], v[198:199], v[254:255]
    v_cvt_pk_bf16_f32 v138, v140, v141
    v_cvt_pk_bf16_f32 v139, v142, v143
    v_cvt_pk_bf16_f32 v84, v84, v85
    v_cvt_pk_bf16_f32 v85, v86, v87
    v_cvt_pk_bf16_f32 v194, v196, v197
    v_cvt_pk_bf16_f32 v195, v198, v199
    ds_read_b128 v[248:251], v5 offset:192
    ds_read_b128 v[252:255], v5 offset:1216
    v_pk_fma_f32 v[144:145], v[34:35], v[76:77], v[144:145] op_sel:[0,0,0] op_sel_hi:[0,1,1]
    v_pk_fma_f32 v[146:147], v[34:35], v[78:79], v[146:147] op_sel:[0,0,0] op_sel_hi:[0,1,1]
    v_pk_fma_f32 v[88:89], v[34:35], v[72:73], v[88:89] op_sel:[0,0,0] op_sel_hi:[0,1,1]
    v_pk_fma_f32 v[90:91], v[34:35], v[74:75], v[90:91] op_sel:[0,0,0] op_sel_hi:[0,1,1]
    v_pk_mul_f32 v[144:145], v[144:145], v[48:49] op_sel:[0,0] op_sel_hi:[1,0]
    v_pk_mul_f32 v[146:147], v[146:147], v[48:49] op_sel:[0,0] op_sel_hi:[1,0]
    s_waitcnt lgkmcnt(2)
    v_pk_fma_f32 v[200:201], v[60:61], v[80:81], v[200:201] op_sel_hi:[1,0,1]
    v_pk_fma_f32 v[202:203], v[62:63], v[80:81], v[202:203] op_sel_hi:[1,0,1]
    v_pk_mul_f32 v[200:201], v[200:201], v[64:65]
    v_pk_mul_f32 v[202:203], v[202:203], v[66:67]
    v_cvt_pk_bf16_f32 v140, v144, v145
    v_cvt_pk_bf16_f32 v141, v146, v147
    v_cvt_pk_bf16_f32 v86, v88, v89
    v_cvt_pk_bf16_f32 v87, v90, v91
    v_cvt_pk_bf16_f32 v196, v200, v201
    v_cvt_pk_bf16_f32 v197, v202, v203
    ds_read_b128 v[60:63], v5 offset:256
    ds_read_b128 v[64:67], v5 offset:1280
    v_pk_fma_f32 v[148:149], v[34:35], v[76:77], v[148:149] op_sel:[1,0,0] op_sel_hi:[1,1,1]
    v_pk_fma_f32 v[150:151], v[34:35], v[78:79], v[150:151] op_sel:[1,0,0] op_sel_hi:[1,1,1]
    v_pk_fma_f32 v[92:93], v[34:35], v[72:73], v[92:93] op_sel:[1,0,0] op_sel_hi:[1,1,1]
    v_pk_fma_f32 v[94:95], v[34:35], v[74:75], v[94:95] op_sel:[1,0,0] op_sel_hi:[1,1,1]
    v_pk_mul_f32 v[148:149], v[148:149], v[48:49] op_sel:[0,1] op_sel_hi:[1,1]
    v_pk_mul_f32 v[150:151], v[150:151], v[48:49] op_sel:[0,1] op_sel_hi:[1,1]
    s_waitcnt lgkmcnt(2)
    v_pk_fma_f32 v[204:205], v[248:249], v[80:81], v[204:205] op_sel_hi:[1,0,1]
    v_pk_fma_f32 v[206:207], v[250:251], v[80:81], v[206:207] op_sel_hi:[1,0,1]
    v_pk_mul_f32 v[204:205], v[204:205], v[252:253]
    v_pk_mul_f32 v[206:207], v[206:207], v[254:255]
    v_cvt_pk_bf16_f32 v142, v148, v149
    v_cvt_pk_bf16_f32 v143, v150, v151
    v_cvt_pk_bf16_f32 v88, v92, v93
    v_cvt_pk_bf16_f32 v89, v94, v95
    v_cvt_pk_bf16_f32 v198, v204, v205
    v_cvt_pk_bf16_f32 v199, v206, v207
    ds_read_b128 v[248:251], v5 offset:320
    ds_read_b128 v[252:255], v5 offset:1344
    v_pk_fma_f32 v[152:153], v[36:37], v[76:77], v[152:153] op_sel:[0,0,0] op_sel_hi:[0,1,1]
    v_pk_fma_f32 v[154:155], v[36:37], v[78:79], v[154:155] op_sel:[0,0,0] op_sel_hi:[0,1,1]
    v_pk_fma_f32 v[96:97], v[36:37], v[72:73], v[96:97] op_sel:[0,0,0] op_sel_hi:[0,1,1]
    v_pk_fma_f32 v[98:99], v[36:37], v[74:75], v[98:99] op_sel:[0,0,0] op_sel_hi:[0,1,1]
    v_pk_mul_f32 v[152:153], v[152:153], v[50:51] op_sel:[0,0] op_sel_hi:[1,0]
    v_pk_mul_f32 v[154:155], v[154:155], v[50:51] op_sel:[0,0] op_sel_hi:[1,0]
    s_waitcnt lgkmcnt(2)
    v_pk_fma_f32 v[208:209], v[60:61], v[80:81], v[208:209] op_sel_hi:[1,0,1]
    v_pk_fma_f32 v[210:211], v[62:63], v[80:81], v[210:211] op_sel_hi:[1,0,1]
    v_pk_mul_f32 v[208:209], v[208:209], v[64:65]
    v_pk_mul_f32 v[210:211], v[210:211], v[66:67]
    v_cvt_pk_bf16_f32 v144, v152, v153
    v_cvt_pk_bf16_f32 v145, v154, v155
    v_cvt_pk_bf16_f32 v90, v96, v97
    v_cvt_pk_bf16_f32 v91, v98, v99
    v_cvt_pk_bf16_f32 v200, v208, v209
    v_cvt_pk_bf16_f32 v201, v210, v211
    ds_read_b128 v[60:63], v5 offset:384
    ds_read_b128 v[64:67], v5 offset:1408
    v_pk_fma_f32 v[156:157], v[36:37], v[76:77], v[156:157] op_sel:[1,0,0] op_sel_hi:[1,1,1]
    v_pk_fma_f32 v[158:159], v[36:37], v[78:79], v[158:159] op_sel:[1,0,0] op_sel_hi:[1,1,1]
    v_pk_fma_f32 v[100:101], v[36:37], v[72:73], v[100:101] op_sel:[1,0,0] op_sel_hi:[1,1,1]
    v_pk_fma_f32 v[102:103], v[36:37], v[74:75], v[102:103] op_sel:[1,0,0] op_sel_hi:[1,1,1]
    v_pk_mul_f32 v[156:157], v[156:157], v[50:51] op_sel:[0,1] op_sel_hi:[1,1]
    v_pk_mul_f32 v[158:159], v[158:159], v[50:51] op_sel:[0,1] op_sel_hi:[1,1]
    s_waitcnt lgkmcnt(2)
    v_pk_fma_f32 v[212:213], v[248:249], v[80:81], v[212:213] op_sel_hi:[1,0,1]
    v_pk_fma_f32 v[214:215], v[250:251], v[80:81], v[214:215] op_sel_hi:[1,0,1]
    v_pk_mul_f32 v[212:213], v[212:213], v[252:253]
    v_pk_mul_f32 v[214:215], v[214:215], v[254:255]
    v_cvt_pk_bf16_f32 v146, v156, v157
    v_cvt_pk_bf16_f32 v147, v158, v159
    v_cvt_pk_bf16_f32 v92, v100, v101
    v_cvt_pk_bf16_f32 v93, v102, v103
    v_cvt_pk_bf16_f32 v202, v212, v213
    v_cvt_pk_bf16_f32 v203, v214, v215
    ds_read_b128 v[248:251], v5 offset:448
    ds_read_b128 v[252:255], v5 offset:1472
    v_pk_fma_f32 v[160:161], v[38:39], v[76:77], v[160:161] op_sel:[0,0,0] op_sel_hi:[0,1,1]
    v_pk_fma_f32 v[162:163], v[38:39], v[78:79], v[162:163] op_sel:[0,0,0] op_sel_hi:[0,1,1]
    v_pk_fma_f32 v[104:105], v[38:39], v[72:73], v[104:105] op_sel:[0,0,0] op_sel_hi:[0,1,1]
    v_pk_fma_f32 v[106:107], v[38:39], v[74:75], v[106:107] op_sel:[0,0,0] op_sel_hi:[0,1,1]
    v_pk_mul_f32 v[160:161], v[160:161], v[52:53] op_sel:[0,0] op_sel_hi:[1,0]
    v_pk_mul_f32 v[162:163], v[162:163], v[52:53] op_sel:[0,0] op_sel_hi:[1,0]
    s_waitcnt lgkmcnt(2)
    v_pk_fma_f32 v[216:217], v[60:61], v[80:81], v[216:217] op_sel_hi:[1,0,1]
    v_pk_fma_f32 v[218:219], v[62:63], v[80:81], v[218:219] op_sel_hi:[1,0,1]
    v_pk_mul_f32 v[216:217], v[216:217], v[64:65]
    v_pk_mul_f32 v[218:219], v[218:219], v[66:67]
    v_cvt_pk_bf16_f32 v148, v160, v161
    v_cvt_pk_bf16_f32 v149, v162, v163
    v_cvt_pk_bf16_f32 v94, v104, v105
    v_cvt_pk_bf16_f32 v95, v106, v107
    v_cvt_pk_bf16_f32 v204, v216, v217
    v_cvt_pk_bf16_f32 v205, v218, v219
    ds_read_b128 v[60:63], v5 offset:512
    ds_read_b128 v[64:67], v5 offset:1536
    v_pk_fma_f32 v[164:165], v[38:39], v[76:77], v[164:165] op_sel:[1,0,0] op_sel_hi:[1,1,1]
    v_pk_fma_f32 v[166:167], v[38:39], v[78:79], v[166:167] op_sel:[1,0,0] op_sel_hi:[1,1,1]
    v_pk_fma_f32 v[108:109], v[38:39], v[72:73], v[108:109] op_sel:[1,0,0] op_sel_hi:[1,1,1]
    v_pk_fma_f32 v[110:111], v[38:39], v[74:75], v[110:111] op_sel:[1,0,0] op_sel_hi:[1,1,1]
    v_pk_mul_f32 v[164:165], v[164:165], v[52:53] op_sel:[0,1] op_sel_hi:[1,1]
    v_pk_mul_f32 v[166:167], v[166:167], v[52:53] op_sel:[0,1] op_sel_hi:[1,1]
    s_waitcnt lgkmcnt(2)
    v_pk_fma_f32 v[220:221], v[248:249], v[80:81], v[220:221] op_sel_hi:[1,0,1]
    v_pk_fma_f32 v[222:223], v[250:251], v[80:81], v[222:223] op_sel_hi:[1,0,1]
    v_pk_mul_f32 v[220:221], v[220:221], v[252:253]
    v_pk_mul_f32 v[222:223], v[222:223], v[254:255]
    v_cvt_pk_bf16_f32 v150, v164, v165
    v_cvt_pk_bf16_f32 v151, v166, v167
    v_cvt_pk_bf16_f32 v96, v108, v109
    v_cvt_pk_bf16_f32 v97, v110, v111
    v_cvt_pk_bf16_f32 v206, v220, v221
    v_cvt_pk_bf16_f32 v207, v222, v223
    ds_read_b128 v[248:251], v5 offset:576
    ds_read_b128 v[252:255], v5 offset:1600
    v_pk_fma_f32 v[168:169], v[40:41], v[76:77], v[168:169] op_sel:[0,0,0] op_sel_hi:[0,1,1]
    v_pk_fma_f32 v[170:171], v[40:41], v[78:79], v[170:171] op_sel:[0,0,0] op_sel_hi:[0,1,1]
    v_pk_fma_f32 v[112:113], v[40:41], v[72:73], v[112:113] op_sel:[0,0,0] op_sel_hi:[0,1,1]
    v_pk_fma_f32 v[114:115], v[40:41], v[74:75], v[114:115] op_sel:[0,0,0] op_sel_hi:[0,1,1]
    v_pk_mul_f32 v[168:169], v[168:169], v[54:55] op_sel:[0,0] op_sel_hi:[1,0]
    v_pk_mul_f32 v[170:171], v[170:171], v[54:55] op_sel:[0,0] op_sel_hi:[1,0]
    s_waitcnt lgkmcnt(2)
    v_pk_fma_f32 v[224:225], v[60:61], v[80:81], v[224:225] op_sel_hi:[1,0,1]
    v_pk_fma_f32 v[226:227], v[62:63], v[80:81], v[226:227] op_sel_hi:[1,0,1]
    v_pk_mul_f32 v[224:225], v[224:225], v[64:65]
    v_pk_mul_f32 v[226:227], v[226:227], v[66:67]
    v_cvt_pk_bf16_f32 v152, v168, v169
    v_cvt_pk_bf16_f32 v153, v170, v171
    v_cvt_pk_bf16_f32 v98, v112, v113
    v_cvt_pk_bf16_f32 v99, v114, v115
    v_cvt_pk_bf16_f32 v208, v224, v225
    v_cvt_pk_bf16_f32 v209, v226, v227
    ds_read_b128 v[60:63], v5 offset:640
    ds_read_b128 v[64:67], v5 offset:1664
    v_pk_fma_f32 v[172:173], v[40:41], v[76:77], v[172:173] op_sel:[1,0,0] op_sel_hi:[1,1,1]
    v_pk_fma_f32 v[174:175], v[40:41], v[78:79], v[174:175] op_sel:[1,0,0] op_sel_hi:[1,1,1]
    v_pk_fma_f32 v[116:117], v[40:41], v[72:73], v[116:117] op_sel:[1,0,0] op_sel_hi:[1,1,1]
    v_pk_fma_f32 v[118:119], v[40:41], v[74:75], v[118:119] op_sel:[1,0,0] op_sel_hi:[1,1,1]
    v_pk_mul_f32 v[172:173], v[172:173], v[54:55] op_sel:[0,1] op_sel_hi:[1,1]
    v_pk_mul_f32 v[174:175], v[174:175], v[54:55] op_sel:[0,1] op_sel_hi:[1,1]
    s_waitcnt lgkmcnt(2)
    v_pk_fma_f32 v[228:229], v[248:249], v[80:81], v[228:229] op_sel_hi:[1,0,1]
    v_pk_fma_f32 v[230:231], v[250:251], v[80:81], v[230:231] op_sel_hi:[1,0,1]
    v_pk_mul_f32 v[228:229], v[228:229], v[252:253]
    v_pk_mul_f32 v[230:231], v[230:231], v[254:255]
    v_cvt_pk_bf16_f32 v154, v172, v173
    v_cvt_pk_bf16_f32 v155, v174, v175
    v_cvt_pk_bf16_f32 v100, v116, v117
    v_cvt_pk_bf16_f32 v101, v118, v119
    v_cvt_pk_bf16_f32 v210, v228, v229
    v_cvt_pk_bf16_f32 v211, v230, v231
    ds_read_b128 v[248:251], v5 offset:704
    ds_read_b128 v[252:255], v5 offset:1728
    v_pk_fma_f32 v[176:177], v[42:43], v[76:77], v[176:177] op_sel:[0,0,0] op_sel_hi:[0,1,1]
    v_pk_fma_f32 v[178:179], v[42:43], v[78:79], v[178:179] op_sel:[0,0,0] op_sel_hi:[0,1,1]
    v_pk_fma_f32 v[120:121], v[42:43], v[72:73], v[120:121] op_sel:[0,0,0] op_sel_hi:[0,1,1]
    v_pk_fma_f32 v[122:123], v[42:43], v[74:75], v[122:123] op_sel:[0,0,0] op_sel_hi:[0,1,1]
    v_pk_mul_f32 v[176:177], v[176:177], v[56:57] op_sel:[0,0] op_sel_hi:[1,0]
    v_pk_mul_f32 v[178:179], v[178:179], v[56:57] op_sel:[0,0] op_sel_hi:[1,0]
    s_waitcnt lgkmcnt(2)
    v_pk_fma_f32 v[232:233], v[60:61], v[80:81], v[232:233] op_sel_hi:[1,0,1]
    v_pk_fma_f32 v[234:235], v[62:63], v[80:81], v[234:235] op_sel_hi:[1,0,1]
    v_pk_mul_f32 v[232:233], v[232:233], v[64:65]
    v_pk_mul_f32 v[234:235], v[234:235], v[66:67]
    v_cvt_pk_bf16_f32 v156, v176, v177
    v_cvt_pk_bf16_f32 v157, v178, v179
    v_cvt_pk_bf16_f32 v102, v120, v121
    v_cvt_pk_bf16_f32 v103, v122, v123
    v_cvt_pk_bf16_f32 v212, v232, v233
    v_cvt_pk_bf16_f32 v213, v234, v235
    ds_read_b128 v[60:63], v5 offset:768
    ds_read_b128 v[64:67], v5 offset:1792
    v_pk_fma_f32 v[180:181], v[42:43], v[76:77], v[180:181] op_sel:[1,0,0] op_sel_hi:[1,1,1]
    v_pk_fma_f32 v[182:183], v[42:43], v[78:79], v[182:183] op_sel:[1,0,0] op_sel_hi:[1,1,1]
    v_pk_fma_f32 v[124:125], v[42:43], v[72:73], v[124:125] op_sel:[1,0,0] op_sel_hi:[1,1,1]
    v_pk_fma_f32 v[126:127], v[42:43], v[74:75], v[126:127] op_sel:[1,0,0] op_sel_hi:[1,1,1]
    v_pk_mul_f32 v[180:181], v[180:181], v[56:57] op_sel:[0,1] op_sel_hi:[1,1]
    v_pk_mul_f32 v[182:183], v[182:183], v[56:57] op_sel:[0,1] op_sel_hi:[1,1]
    s_waitcnt lgkmcnt(2)
    v_pk_fma_f32 v[236:237], v[248:249], v[80:81], v[236:237] op_sel_hi:[1,0,1]
    v_pk_fma_f32 v[238:239], v[250:251], v[80:81], v[238:239] op_sel_hi:[1,0,1]
    v_pk_mul_f32 v[236:237], v[236:237], v[252:253]
    v_pk_mul_f32 v[238:239], v[238:239], v[254:255]
    v_cvt_pk_bf16_f32 v158, v180, v181
    v_cvt_pk_bf16_f32 v159, v182, v183
    v_cvt_pk_bf16_f32 v104, v124, v125
    v_cvt_pk_bf16_f32 v105, v126, v127
    v_cvt_pk_bf16_f32 v214, v236, v237
    v_cvt_pk_bf16_f32 v215, v238, v239
    ds_read_b128 v[248:251], v5 offset:832
    ds_read_b128 v[252:255], v5 offset:1856
    v_pk_fma_f32 v[184:185], v[44:45], v[76:77], v[184:185] op_sel:[0,0,0] op_sel_hi:[0,1,1]
    v_pk_fma_f32 v[186:187], v[44:45], v[78:79], v[186:187] op_sel:[0,0,0] op_sel_hi:[0,1,1]
    v_pk_fma_f32 v[128:129], v[44:45], v[72:73], v[128:129] op_sel:[0,0,0] op_sel_hi:[0,1,1]
    v_pk_fma_f32 v[130:131], v[44:45], v[74:75], v[130:131] op_sel:[0,0,0] op_sel_hi:[0,1,1]
    v_pk_mul_f32 v[184:185], v[184:185], v[58:59] op_sel:[0,0] op_sel_hi:[1,0]
    v_pk_mul_f32 v[186:187], v[186:187], v[58:59] op_sel:[0,0] op_sel_hi:[1,0]
    s_waitcnt lgkmcnt(2)
    v_pk_fma_f32 v[240:241], v[60:61], v[80:81], v[240:241] op_sel_hi:[1,0,1]
    v_pk_fma_f32 v[242:243], v[62:63], v[80:81], v[242:243] op_sel_hi:[1,0,1]
    v_pk_mul_f32 v[240:241], v[240:241], v[64:65]
    v_pk_mul_f32 v[242:243], v[242:243], v[66:67]
    v_cvt_pk_bf16_f32 v160, v184, v185
    v_cvt_pk_bf16_f32 v161, v186, v187
    v_cvt_pk_bf16_f32 v106, v128, v129
    v_cvt_pk_bf16_f32 v107, v130, v131
    v_cvt_pk_bf16_f32 v216, v240, v241
    v_cvt_pk_bf16_f32 v217, v242, v243
    v_pk_fma_f32 v[188:189], v[44:45], v[76:77], v[188:189] op_sel:[1,0,0] op_sel_hi:[1,1,1]
    v_pk_fma_f32 v[190:191], v[44:45], v[78:79], v[190:191] op_sel:[1,0,0] op_sel_hi:[1,1,1]
    v_pk_fma_f32 v[132:133], v[44:45], v[72:73], v[132:133] op_sel:[1,0,0] op_sel_hi:[1,1,1]
    v_pk_fma_f32 v[134:135], v[44:45], v[74:75], v[134:135] op_sel:[1,0,0] op_sel_hi:[1,1,1]
    v_pk_mul_f32 v[188:189], v[188:189], v[58:59] op_sel:[0,1] op_sel_hi:[1,1]
    v_pk_mul_f32 v[190:191], v[190:191], v[58:59] op_sel:[0,1] op_sel_hi:[1,1]
    s_waitcnt lgkmcnt(0)
    v_pk_fma_f32 v[244:245], v[248:249], v[80:81], v[244:245] op_sel_hi:[1,0,1]
    v_pk_fma_f32 v[246:247], v[250:251], v[80:81], v[246:247] op_sel_hi:[1,0,1]
    v_pk_mul_f32 v[244:245], v[244:245], v[252:253]
    v_pk_mul_f32 v[246:247], v[246:247], v[254:255]
    v_cvt_pk_bf16_f32 v162, v188, v189
    v_cvt_pk_bf16_f32 v163, v190, v191
    v_cvt_pk_bf16_f32 v108, v132, v133
    v_cvt_pk_bf16_f32 v109, v134, v135
    v_cvt_pk_bf16_f32 v218, v244, v245
    v_cvt_pk_bf16_f32 v219, v246, v247
    v_and_b32 v2, 15, v1
    v_lshrrev_b32 v3, 4, v1
    v_lshlrev_b32 v3, 2, v3
    v_sub_u32 v2, v2, v3
    v_mov_b32 v6, 0xff800000
    v_mov_b32 v7, 0
    v_subrev_u32 v3, 0, v2
    v_and_b32 v8, 1, v3
    v_cmp_eq_u32 s[48:49], 0, v8
    v_cmp_le_i32 s[50:51], 0, v3
    s_and_b64 s[50:51], s[50:51], s[48:49]
    v_cmp_ge_i32 s[52:53], -2, v3
    s_and_b64 s[52:53], s[52:53], s[48:49]
    s_nop 1
    v_cndmask_b32 v64, v6, v7, s[50:51]
    v_cndmask_b32 v60, v6, v7, s[52:53]
    v_subrev_u32 v3, 1, v2
    v_and_b32 v8, 1, v3
    v_cmp_eq_u32 s[48:49], 0, v8
    v_cmp_le_i32 s[50:51], 0, v3
    s_and_b64 s[50:51], s[50:51], s[48:49]
    v_cmp_ge_i32 s[52:53], -2, v3
    s_and_b64 s[52:53], s[52:53], s[48:49]
    s_nop 1
    v_cndmask_b32 v65, v6, v7, s[50:51]
    v_cndmask_b32 v61, v6, v7, s[52:53]
    v_subrev_u32 v3, 2, v2
    v_and_b32 v8, 1, v3
    v_cmp_eq_u32 s[48:49], 0, v8
    v_cmp_le_i32 s[50:51], 0, v3
    s_and_b64 s[50:51], s[50:51], s[48:49]
    v_cmp_ge_i32 s[52:53], -2, v3
    s_and_b64 s[52:53], s[52:53], s[48:49]
    s_nop 1
    v_cndmask_b32 v66, v6, v7, s[50:51]
    v_cndmask_b32 v62, v6, v7, s[52:53]
    v_subrev_u32 v3, 3, v2
    v_and_b32 v8, 1, v3
    v_cmp_eq_u32 s[48:49], 0, v8
    v_cmp_le_i32 s[50:51], 0, v3
    s_and_b64 s[50:51], s[50:51], s[48:49]
    v_cmp_ge_i32 s[52:53], -2, v3
    s_and_b64 s[52:53], s[52:53], s[48:49]
    s_nop 1
    v_cndmask_b32 v67, v6, v7, s[50:51]
    v_cndmask_b32 v63, v6, v7, s[52:53]
    s_cmp_eq_u32 s76, 0
    s_cselect_b32 s48, 0xff800000, 0
    v_min_f32 v68, s48, v60
    v_min_f32 v69, s48, v61
    v_min_f32 v70, s48, v62
    v_min_f32 v71, s48, v63
    v_and_b32 v2, 15, v1
    v_lshlrev_b32 v24, 4, v2
    v_lshrrev_b32 v3, 5, v1
    v_lshl_add_u32 v24, v3, 9, v24
    v_bfe_u32 v3, v1, 4, 1
    v_lshl_add_u32 v24, v3, 3, v24
    v_mul_f32 v47, 0x3eb8aa3b, v47
    v_mul_f32 v48, 0x3eb8aa3b, v48
    v_mul_f32 v49, 0x3eb8aa3b, v49
    v_mul_f32 v50, 0x3eb8aa3b, v50
    v_mul_f32 v51, 0x3eb8aa3b, v51
    v_mul_f32 v52, 0x3eb8aa3b, v52
    v_mul_f32 v53, 0x3eb8aa3b, v53
    v_mul_f32 v54, 0x3eb8aa3b, v54
    v_mul_f32 v55, 0x3eb8aa3b, v55
    v_mul_f32 v56, 0x3eb8aa3b, v56
    v_mul_f32 v57, 0x3eb8aa3b, v57
    v_mul_f32 v58, 0x3eb8aa3b, v58
    v_mul_f32 v59, 0x3eb8aa3b, v59
    s_add_u32 s40, s24, 0x400000
    s_addc_u32 s41, s25, 0
    s_and_b32 s41, s41, 0xffff
    s_mov_b32 s42, 0x200000
    s_mov_b32 s43, 0x20000
    s_lshl_b32 s52, s77, 2
    s_add_u32 s52, s52, s26
    s_lshl_b32 s52, s52, 10
    s_mul_i32 s53, s76, 13
    s_add_u32 s48, s53, 0
    s_lshr_b32 s49, s48, 1
    s_lshl_b32 s49, s49, 15
    s_and_b32 s48, s48, 1
    s_lshl_b32 s48, s48, 8
    s_add_u32 s49, s49, s48
    s_add_u32 s54, s49, s52
    s_add_u32 s48, s53, 1
    s_lshr_b32 s49, s48, 1
    s_lshl_b32 s49, s49, 15
    s_and_b32 s48, s48, 1
    s_lshl_b32 s48, s48, 8
    s_add_u32 s49, s49, s48
    s_add_u32 s55, s49, s52
    s_nop 1
    v_mfma_f32_16x16x16_bf16 v[110:113], v[136:137], v[84:85], 0
    v_mfma_f32_16x16x16_bf16 v[114:117], v[138:139], v[84:85], 0
    v_mfma_f32_16x16x16_bf16 v[126:129], v[138:139], v[86:87], 0
    v_mfma_f32_16x16x16_bf16 v[130:133], v[140:141], v[86:87], 0
    v_mfma_f32_16x16x16_bf16 v[172:175], v[140:141], v[88:89], 0
    v_mfma_f32_16x16x16_bf16 v[176:179], v[142:143], v[88:89], 0
    v_mfma_f32_16x16x16_bf16 v[188:191], v[142:143], v[90:91], 0
    v_mfma_f32_16x16x16_bf16 v[220:223], v[144:145], v[90:91], 0
    s_nop 1
    v_pk_fma_f32 v[110:111], v[110:111], v[46:47], v[68:69] op_sel:[0,1,0] op_sel_hi:[1,1,1]
    v_pk_fma_f32 v[112:113], v[112:113], v[46:47], v[70:71] op_sel:[0,1,0] op_sel_hi:[1,1,1]
    v_pk_fma_f32 v[114:115], v[114:115], v[46:47], v[64:65] op_sel:[0,1,0] op_sel_hi:[1,1,1]
    v_pk_fma_f32 v[116:117], v[116:117], v[46:47], v[66:67] op_sel:[0,1,0] op_sel_hi:[1,1,1]
    v_pk_fma_f32 v[126:127], v[126:127], v[48:49], v[60:61] op_sel:[0,0,0] op_sel_hi:[1,0,1]
    v_pk_fma_f32 v[128:129], v[128:129], v[48:49], v[62:63] op_sel:[0,0,0] op_sel_hi:[1,0,1]
    v_pk_fma_f32 v[130:131], v[130:131], v[48:49], v[64:65] op_sel:[0,0,0] op_sel_hi:[1,0,1]
    v_pk_fma_f32 v[132:133], v[132:133], v[48:49], v[66:67] op_sel:[0,0,0] op_sel_hi:[1,0,1]
    v_pk_fma_f32 v[172:173], v[172:173], v[48:49], v[60:61] op_sel:[0,1,0] op_sel_hi:[1,1,1]
    v_pk_fma_f32 v[174:175], v[174:175], v[48:49], v[62:63] op_sel:[0,1,0] op_sel_hi:[1,1,1]
    v_pk_fma_f32 v[176:177], v[176:177], v[48:49], v[64:65] op_sel:[0,1,0] op_sel_hi:[1,1,1]
    v_pk_fma_f32 v[178:179], v[178:179], v[48:49], v[66:67] op_sel:[0,1,0] op_sel_hi:[1,1,1]
    v_pk_fma_f32 v[188:189], v[188:189], v[50:51], v[60:61] op_sel:[0,0,0] op_sel_hi:[1,0,1]
    v_pk_fma_f32 v[190:191], v[190:191], v[50:51], v[62:63] op_sel:[0,0,0] op_sel_hi:[1,0,1]
    v_pk_fma_f32 v[220:221], v[220:221], v[50:51], v[64:65] op_sel:[0,0,0] op_sel_hi:[1,0,1]
    v_pk_fma_f32 v[222:223], v[222:223], v[50:51], v[66:67] op_sel:[0,0,0] op_sel_hi:[1,0,1]
    v_max3_f32 v118, v110, v111, v112
    v_max3_f32 v119, v114, v115, v116
    v_max3_f32 v118, v118, v113, v117
    v_max_f32 v118, v118, v119
    v_max3_f32 v164, v126, v127, v128
    v_max3_f32 v165, v130, v131, v132
    v_max3_f32 v164, v164, v129, v133
    v_max_f32 v164, v164, v165
    v_max3_f32 v180, v172, v173, v174
    v_max3_f32 v181, v176, v177, v178
    v_max3_f32 v180, v180, v175, v179
    v_max_f32 v180, v180, v181
    v_max3_f32 v224, v188, v189, v190
    v_max3_f32 v225, v220, v221, v222
    v_max3_f32 v224, v224, v191, v223
    v_max_f32 v224, v224, v225
    v_mov_b32 v119, v118
    v_mov_b32 v165, v164
    v_mov_b32 v181, v180
    v_mov_b32 v225, v224
    v_permlane16_swap_b32 v118, v119
    v_permlane16_swap_b32 v164, v165
    v_permlane16_swap_b32 v180, v181
    v_permlane16_swap_b32 v224, v225
    v_max_f32 v118, v118, v119
    v_max_f32 v164, v164, v165
    v_max_f32 v180, v180, v181
    v_max_f32 v224, v224, v225
    v_mov_b32 v119, v118
    v_mov_b32 v165, v164
    v_mov_b32 v181, v180
    v_mov_b32 v225, v224
    v_permlane32_swap_b32 v118, v119
    v_permlane32_swap_b32 v164, v165
    v_permlane32_swap_b32 v180, v181
    v_permlane32_swap_b32 v224, v225
    v_max_f32 v118, v118, v119
    v_max_f32 v164, v164, v165
    v_max_f32 v180, v180, v181
    v_max_f32 v224, v224, v225
    v_pk_add_f32 v[110:111], v[110:111], v[118:119] op_sel_hi:[1,0] neg_lo:[0,1] neg_hi:[0,1]
    v_pk_add_f32 v[112:113], v[112:113], v[118:119] op_sel_hi:[1,0] neg_lo:[0,1] neg_hi:[0,1]
    v_pk_add_f32 v[114:115], v[114:115], v[118:119] op_sel_hi:[1,0] neg_lo:[0,1] neg_hi:[0,1]
    v_pk_add_f32 v[116:117], v[116:117], v[118:119] op_sel_hi:[1,0] neg_lo:[0,1] neg_hi:[0,1]
    v_pk_add_f32 v[126:127], v[126:127], v[164:165] op_sel_hi:[1,0] neg_lo:[0,1] neg_hi:[0,1]
    v_pk_add_f32 v[128:129], v[128:129], v[164:165] op_sel_hi:[1,0] neg_lo:[0,1] neg_hi:[0,1]
    v_pk_add_f32 v[130:131], v[130:131], v[164:165] op_sel_hi:[1,0] neg_lo:[0,1] neg_hi:[0,1]
    v_pk_add_f32 v[132:133], v[132:133], v[164:165] op_sel_hi:[1,0] neg_lo:[0,1] neg_hi:[0,1]
    v_pk_add_f32 v[172:173], v[172:173], v[180:181] op_sel_hi:[1,0] neg_lo:[0,1] neg_hi:[0,1]
    v_pk_add_f32 v[174:175], v[174:175], v[180:181] op_sel_hi:[1,0] neg_lo:[0,1] neg_hi:[0,1]
    v_pk_add_f32 v[176:177], v[176:177], v[180:181] op_sel_hi:[1,0] neg_lo:[0,1] neg_hi:[0,1]
    v_pk_add_f32 v[178:179], v[178:179], v[180:181] op_sel_hi:[1,0] neg_lo:[0,1] neg_hi:[0,1]
    v_pk_add_f32 v[188:189], v[188:189], v[224:225] op_sel_hi:[1,0] neg_lo:[0,1] neg_hi:[0,1]
    v_pk_add_f32 v[190:191], v[190:191], v[224:225] op_sel_hi:[1,0] neg_lo:[0,1] neg_hi:[0,1]
    v_pk_add_f32 v[220:221], v[220:221], v[224:225] op_sel_hi:[1,0] neg_lo:[0,1] neg_hi:[0,1]
    v_pk_add_f32 v[222:223], v[222:223], v[224:225] op_sel_hi:[1,0] neg_lo:[0,1] neg_hi:[0,1]
    v_exp_f32 v110, v110
    v_exp_f32 v111, v111
    v_exp_f32 v112, v112
    v_exp_f32 v113, v113
    v_exp_f32 v114, v114
    v_exp_f32 v115, v115
    v_exp_f32 v116, v116
    v_exp_f32 v117, v117
    v_exp_f32 v126, v126
    v_exp_f32 v127, v127
    v_exp_f32 v128, v128
    v_exp_f32 v129, v129
    v_exp_f32 v130, v130
    v_exp_f32 v131, v131
    v_exp_f32 v132, v132
    v_exp_f32 v133, v133
    v_exp_f32 v172, v172
    v_exp_f32 v173, v173
    v_exp_f32 v174, v174
    v_exp_f32 v175, v175
    v_exp_f32 v176, v176
    v_exp_f32 v177, v177
    v_exp_f32 v178, v178
    v_exp_f32 v179, v179
    v_exp_f32 v188, v188
    v_exp_f32 v189, v189
    v_exp_f32 v190, v190
    v_exp_f32 v191, v191
    v_exp_f32 v220, v220
    v_exp_f32 v221, v221
    v_exp_f32 v222, v222
    v_exp_f32 v223, v223
    v_cvt_pk_bf16_f32 v118, v110, v111
    v_cvt_pk_bf16_f32 v119, v112, v113
    v_cvt_pk_bf16_f32 v120, v114, v115
    v_cvt_pk_bf16_f32 v121, v116, v117
    v_cvt_pk_bf16_f32 v164, v126, v127
    v_cvt_pk_bf16_f32 v165, v128, v129
    v_cvt_pk_bf16_f32 v166, v130, v131
    v_cvt_pk_bf16_f32 v167, v132, v133
    v_cvt_pk_bf16_f32 v180, v172, v173
    v_cvt_pk_bf16_f32 v181, v174, v175
    v_cvt_pk_bf16_f32 v182, v176, v177
    v_cvt_pk_bf16_f32 v183, v178, v179
    v_cvt_pk_bf16_f32 v224, v188, v189
    v_cvt_pk_bf16_f32 v225, v190, v191
    v_cvt_pk_bf16_f32 v226, v220, v221
    v_cvt_pk_bf16_f32 v227, v222, v223
    s_nop 1
    v_mfma_f32_16x16x32_bf16 v[114:117], v[28:31], v[118:121], 0
    v_mfma_f32_16x16x32_bf16 v[110:113], v[192:195], v[118:121], 0
    v_mfma_f32_16x16x32_bf16 v[130:133], v[28:31], v[164:167], 0
    v_mfma_f32_16x16x32_bf16 v[126:129], v[194:197], v[164:167], 0
    v_mfma_f32_16x16x32_bf16 v[176:179], v[28:31], v[180:183], 0
    v_mfma_f32_16x16x32_bf16 v[172:175], v[196:199], v[180:183], 0
    v_mfma_f32_16x16x32_bf16 v[220:223], v[28:31], v[224:227], 0
    v_mfma_f32_16x16x32_bf16 v[188:191], v[198:201], v[224:227], 0
    s_nop 3
    v_rcp_f32 v114, v114
    v_rcp_f32 v130, v130
    v_rcp_f32 v176, v176
    v_rcp_f32 v220, v220
    v_pk_mul_f32 v[110:111], v[110:111], v[114:115] op_sel_hi:[1,0]
    v_pk_mul_f32 v[112:113], v[112:113], v[114:115] op_sel_hi:[1,0]
    v_pk_mul_f32 v[126:127], v[126:127], v[130:131] op_sel_hi:[1,0]
    v_pk_mul_f32 v[128:129], v[128:129], v[130:131] op_sel_hi:[1,0]
    v_pk_mul_f32 v[172:173], v[172:173], v[176:177] op_sel_hi:[1,0]
    v_pk_mul_f32 v[174:175], v[174:175], v[176:177] op_sel_hi:[1,0]
    v_pk_mul_f32 v[188:189], v[188:189], v[220:221] op_sel_hi:[1,0]
    v_pk_mul_f32 v[190:191], v[190:191], v[220:221] op_sel_hi:[1,0]
    v_cvt_pk_bf16_f32 v122, v110, v111
    v_cvt_pk_bf16_f32 v123, v112, v113
    buffer_store_dwordx2 v[122:123], v24, s[40:43], s54 offen sc1
    s_add_u32 s54, s54, 32768
    v_cvt_pk_bf16_f32 v168, v126, v127
    v_cvt_pk_bf16_f32 v169, v128, v129
    buffer_store_dwordx2 v[168:169], v24, s[40:43], s55 offen sc1
    s_add_u32 s55, s55, 32768
    v_cvt_pk_bf16_f32 v184, v172, v173
    v_cvt_pk_bf16_f32 v185, v174, v175
    buffer_store_dwordx2 v[184:185], v24, s[40:43], s54 offen sc1
    s_add_u32 s54, s54, 32768
    v_cvt_pk_bf16_f32 v228, v188, v189
    v_cvt_pk_bf16_f32 v229, v190, v191
    buffer_store_dwordx2 v[228:229], v24, s[40:43], s55 offen sc1
    s_add_u32 s55, s55, 32768
    s_waitcnt vmcnt(6)
    ds_read_b64_tr_b16 a[0:1], v18 offset:0
    ds_read_b64_tr_b16 a[2:3], v18 offset:1024
    ds_read_b64_tr_b16 a[4:5], v19 offset:0
    ds_read_b64_tr_b16 a[6:7], v19 offset:1024
    ds_read_b64_tr_b16 a[8:9], v18 offset:2048
    ds_read_b64_tr_b16 a[10:11], v18 offset:3072
    ds_read_b64_tr_b16 a[12:13], v19 offset:2048
    ds_read_b64_tr_b16 a[14:15], v19 offset:3072
    s_waitcnt lgkmcnt(4)
    ds_read_b64_tr_b16 a[16:17], v18 offset:4096
    ds_read_b64_tr_b16 a[18:19], v18 offset:5120
    ds_read_b64_tr_b16 a[20:21], v19 offset:4096
    ds_read_b64_tr_b16 a[22:23], v19 offset:5120
    ds_read_b64_tr_b16 a[24:25], v18 offset:6144
    ds_read_b64_tr_b16 a[26:27], v18 offset:7168
    ds_read_b64_tr_b16 a[28:29], v19 offset:6144
    ds_read_b64_tr_b16 a[30:31], v19 offset:7168
    s_waitcnt lgkmcnt(4)
    ds_read_b64_tr_b16 a[32:33], v18 offset:8192
    ds_read_b64_tr_b16 a[34:35], v18 offset:9216
    ds_read_b64_tr_b16 a[36:37], v19 offset:8192
    ds_read_b64_tr_b16 a[38:39], v19 offset:9216
    s_waitcnt lgkmcnt(0)
    s_add_u32 m0, s58, 12288
    s_add_u32 s48, s67, 65536
    buffer_load_dwordx4 v9, s[36:39], s67 offen lds
    s_add_u32 m0, s58, 13312
    s_cmp_eq_u32 s48, s61
    buffer_load_dwordx4 v27, s[36:39], s67 offen lds
    s_cselect_b32 s67, s66, s48
    s_add_u32 m0, s58, 14336
    s_add_u32 s48, s67, 65536
    buffer_load_dwordx4 v9, s[36:39], s67 offen lds
    s_add_u32 m0, s58, 15360
    s_cmp_eq_u32 s48, s61
    buffer_load_dwordx4 v27, s[36:39], s67 offen lds
    s_cselect_b32 s67, s66, s48
    s_add_u32 m0, s58, 16384
    s_add_u32 s48, s67, 65536
    buffer_load_dwordx4 v9, s[36:39], s67 offen lds
    s_add_u32 m0, s58, 17408
    s_cmp_eq_u32 s48, s61
    buffer_load_dwordx4 v27, s[36:39], s67 offen lds
    s_cselect_b32 s67, s66, s48
    s_add_u32 m0, s58, 18432
    s_add_u32 s48, s67, 65536
    buffer_load_dwordx4 v9, s[36:39], s67 offen lds
    s_add_u32 m0, s58, 19456
    s_cmp_eq_u32 s48, s61
    buffer_load_dwordx4 v27, s[36:39], s67 offen lds
    s_cselect_b32 s67, s66, s48
    s_add_u32 m0, s58, 20480
    s_add_u32 s48, s67, 65536
    buffer_load_dwordx4 v9, s[36:39], s67 offen lds
    s_add_u32 m0, s58, 21504
    s_cmp_eq_u32 s48, s61
    buffer_load_dwordx4 v27, s[36:39], s67 offen lds
    s_cselect_b32 s67, s66, s48
    s_nop 1
    v_mfma_f32_16x16x16_bf16 v[110:113], v[144:145], v[92:93], 0
    v_mfma_f32_16x16x16_bf16 v[114:117], v[146:147], v[92:93], 0
    v_mfma_f32_16x16x16_bf16 v[126:129], v[146:147], v[94:95], 0
    v_mfma_f32_16x16x16_bf16 v[130:133], v[148:149], v[94:95], 0
    v_mfma_f32_16x16x16_bf16 v[172:175], v[148:149], v[96:97], 0
    v_mfma_f32_16x16x16_bf16 v[176:179], v[150:151], v[96:97], 0
    v_mfma_f32_16x16x16_bf16 v[188:191], v[150:151], v[98:99], 0
    v_mfma_f32_16x16x16_bf16 v[220:223], v[152:153], v[98:99], 0
    s_nop 1
    v_pk_fma_f32 v[110:111], v[110:111], v[50:51], v[60:61] op_sel:[0,1,0] op_sel_hi:[1,1,1]
    v_pk_fma_f32 v[112:113], v[112:113], v[50:51], v[62:63] op_sel:[0,1,0] op_sel_hi:[1,1,1]
    v_pk_fma_f32 v[114:115], v[114:115], v[50:51], v[64:65] op_sel:[0,1,0] op_sel_hi:[1,1,1]
    v_pk_fma_f32 v[116:117], v[116:117], v[50:51], v[66:67] op_sel:[0,1,0] op_sel_hi:[1,1,1]
    v_pk_fma_f32 v[126:127], v[126:127], v[52:53], v[60:61] op_sel:[0,0,0] op_sel_hi:[1,0,1]
    v_pk_fma_f32 v[128:129], v[128:129], v[52:53], v[62:63] op_sel:[0,0,0] op_sel_hi:[1,0,1]
    v_pk_fma_f32 v[130:131], v[130:131], v[52:53], v[64:65] op_sel:[0,0,0] op_sel_hi:[1,0,1]
    v_pk_fma_f32 v[132:133], v[132:133], v[52:53], v[66:67] op_sel:[0,0,0] op_sel_hi:[1,0,1]
    v_pk_fma_f32 v[172:173], v[172:173], v[52:53], v[60:61] op_sel:[0,1,0] op_sel_hi:[1,1,1]
    v_pk_fma_f32 v[174:175], v[174:175], v[52:53], v[62:63] op_sel:[0,1,0] op_sel_hi:[1,1,1]
    v_pk_fma_f32 v[176:177], v[176:177], v[52:53], v[64:65] op_sel:[0,1,0] op_sel_hi:[1,1,1]
    v_pk_fma_f32 v[178:179], v[178:179], v[52:53], v[66:67] op_sel:[0,1,0] op_sel_hi:[1,1,1]
    v_pk_fma_f32 v[188:189], v[188:189], v[54:55], v[60:61] op_sel:[0,0,0] op_sel_hi:[1,0,1]
    v_pk_fma_f32 v[190:191], v[190:191], v[54:55], v[62:63] op_sel:[0,0,0] op_sel_hi:[1,0,1]
    v_pk_fma_f32 v[220:221], v[220:221], v[54:55], v[64:65] op_sel:[0,0,0] op_sel_hi:[1,0,1]
    v_pk_fma_f32 v[222:223], v[222:223], v[54:55], v[66:67] op_sel:[0,0,0] op_sel_hi:[1,0,1]
    v_max3_f32 v118, v110, v111, v112
    v_max3_f32 v119, v114, v115, v116
    v_max3_f32 v118, v118, v113, v117
    v_max_f32 v118, v118, v119
    v_max3_f32 v164, v126, v127, v128
    v_max3_f32 v165, v130, v131, v132
    v_max3_f32 v164, v164, v129, v133
    v_max_f32 v164, v164, v165
    v_max3_f32 v180, v172, v173, v174
    v_max3_f32 v181, v176, v177, v178
    v_max3_f32 v180, v180, v175, v179
    v_max_f32 v180, v180, v181
    v_max3_f32 v224, v188, v189, v190
    v_max3_f32 v225, v220, v221, v222
    v_max3_f32 v224, v224, v191, v223
    v_max_f32 v224, v224, v225
    v_mov_b32 v119, v118
    v_mov_b32 v165, v164
    v_mov_b32 v181, v180
    v_mov_b32 v225, v224
    v_permlane16_swap_b32 v118, v119
    v_permlane16_swap_b32 v164, v165
    v_permlane16_swap_b32 v180, v181
    v_permlane16_swap_b32 v224, v225
    v_max_f32 v118, v118, v119
    v_max_f32 v164, v164, v165
    v_max_f32 v180, v180, v181
    v_max_f32 v224, v224, v225
    v_mov_b32 v119, v118
    v_mov_b32 v165, v164
    v_mov_b32 v181, v180
    v_mov_b32 v225, v224
    v_permlane32_swap_b32 v118, v119
    v_permlane32_swap_b32 v164, v165
    v_permlane32_swap_b32 v180, v181
    v_permlane32_swap_b32 v224, v225
    v_max_f32 v118, v118, v119
    v_max_f32 v164, v164, v165
    v_max_f32 v180, v180, v181
    v_max_f32 v224, v224, v225
    v_pk_add_f32 v[110:111], v[110:111], v[118:119] op_sel_hi:[1,0] neg_lo:[0,1] neg_hi:[0,1]
    v_pk_add_f32 v[112:113], v[112:113], v[118:119] op_sel_hi:[1,0] neg_lo:[0,1] neg_hi:[0,1]
    v_pk_add_f32 v[114:115], v[114:115], v[118:119] op_sel_hi:[1,0] neg_lo:[0,1] neg_hi:[0,1]
    v_pk_add_f32 v[116:117], v[116:117], v[118:119] op_sel_hi:[1,0] neg_lo:[0,1] neg_hi:[0,1]
    v_pk_add_f32 v[126:127], v[126:127], v[164:165] op_sel_hi:[1,0] neg_lo:[0,1] neg_hi:[0,1]
    v_pk_add_f32 v[128:129], v[128:129], v[164:165] op_sel_hi:[1,0] neg_lo:[0,1] neg_hi:[0,1]
    v_pk_add_f32 v[130:131], v[130:131], v[164:165] op_sel_hi:[1,0] neg_lo:[0,1] neg_hi:[0,1]
    v_pk_add_f32 v[132:133], v[132:133], v[164:165] op_sel_hi:[1,0] neg_lo:[0,1] neg_hi:[0,1]
    v_pk_add_f32 v[172:173], v[172:173], v[180:181] op_sel_hi:[1,0] neg_lo:[0,1] neg_hi:[0,1]
    v_pk_add_f32 v[174:175], v[174:175], v[180:181] op_sel_hi:[1,0] neg_lo:[0,1] neg_hi:[0,1]
    v_pk_add_f32 v[176:177], v[176:177], v[180:181] op_sel_hi:[1,0] neg_lo:[0,1] neg_hi:[0,1]
    v_pk_add_f32 v[178:179], v[178:179], v[180:181] op_sel_hi:[1,0] neg_lo:[0,1] neg_hi:[0,1]
    v_pk_add_f32 v[188:189], v[188:189], v[224:225] op_sel_hi:[1,0] neg_lo:[0,1] neg_hi:[0,1]
    v_pk_add_f32 v[190:191], v[190:191], v[224:225] op_sel_hi:[1,0] neg_lo:[0,1] neg_hi:[0,1]
    v_pk_add_f32 v[220:221], v[220:221], v[224:225] op_sel_hi:[1,0] neg_lo:[0,1] neg_hi:[0,1]
    v_pk_add_f32 v[222:223], v[222:223], v[224:225] op_sel_hi:[1,0] neg_lo:[0,1] neg_hi:[0,1]
    v_exp_f32 v110, v110
    v_exp_f32 v111, v111
    v_exp_f32 v112, v112
    v_exp_f32 v113, v113
    v_exp_f32 v114, v114
    v_exp_f32 v115, v115
    v_exp_f32 v116, v116
    v_exp_f32 v117, v117
    v_exp_f32 v126, v126
    v_exp_f32 v127, v127
    v_exp_f32 v128, v128
    v_exp_f32 v129, v129
    v_exp_f32 v130, v130
    v_exp_f32 v131, v131
    v_exp_f32 v132, v132
    v_exp_f32 v133, v133
    v_exp_f32 v172, v172
    v_exp_f32 v173, v173
    v_exp_f32 v174, v174
    v_exp_f32 v175, v175
    v_exp_f32 v176, v176
    v_exp_f32 v177, v177
    v_exp_f32 v178, v178
    v_exp_f32 v179, v179
    v_exp_f32 v188, v188
    v_exp_f32 v189, v189
    v_exp_f32 v190, v190
    v_exp_f32 v191, v191
    v_exp_f32 v220, v220
    v_exp_f32 v221, v221
    v_exp_f32 v222, v222
    v_exp_f32 v223, v223
    v_cvt_pk_bf16_f32 v118, v110, v111
    v_cvt_pk_bf16_f32 v119, v112, v113
    v_cvt_pk_bf16_f32 v120, v114, v115
    v_cvt_pk_bf16_f32 v121, v116, v117
    v_cvt_pk_bf16_f32 v164, v126, v127
    v_cvt_pk_bf16_f32 v165, v128, v129
    v_cvt_pk_bf16_f32 v166, v130, v131
    v_cvt_pk_bf16_f32 v167, v132, v133
    v_cvt_pk_bf16_f32 v180, v172, v173
    v_cvt_pk_bf16_f32 v181, v174, v175
    v_cvt_pk_bf16_f32 v182, v176, v177
    v_cvt_pk_bf16_f32 v183, v178, v179
    v_cvt_pk_bf16_f32 v224, v188, v189
    v_cvt_pk_bf16_f32 v225, v190, v191
    v_cvt_pk_bf16_f32 v226, v220, v221
    v_cvt_pk_bf16_f32 v227, v222, v223
    s_nop 1
    v_mfma_f32_16x16x32_bf16 v[114:117], v[28:31], v[118:121], 0
    v_mfma_f32_16x16x32_bf16 v[110:113], v[200:203], v[118:121], 0
    v_mfma_f32_16x16x32_bf16 v[130:133], v[28:31], v[164:167], 0
    v_mfma_f32_16x16x32_bf16 v[126:129], v[202:205], v[164:167], 0
    v_mfma_f32_16x16x32_bf16 v[176:179], v[28:31], v[180:183], 0
    v_mfma_f32_16x16x32_bf16 v[172:175], v[204:207], v[180:183], 0
    v_mfma_f32_16x16x32_bf16 v[220:223], v[28:31], v[224:227], 0
    v_mfma_f32_16x16x32_bf16 v[188:191], v[206:209], v[224:227], 0
    s_nop 3
    v_rcp_f32 v114, v114
    v_rcp_f32 v130, v130
    v_rcp_f32 v176, v176
    v_rcp_f32 v220, v220
    v_pk_mul_f32 v[110:111], v[110:111], v[114:115] op_sel_hi:[1,0]
    v_pk_mul_f32 v[112:113], v[112:113], v[114:115] op_sel_hi:[1,0]
    v_pk_mul_f32 v[126:127], v[126:127], v[130:131] op_sel_hi:[1,0]
    v_pk_mul_f32 v[128:129], v[128:129], v[130:131] op_sel_hi:[1,0]
    v_pk_mul_f32 v[172:173], v[172:173], v[176:177] op_sel_hi:[1,0]
    v_pk_mul_f32 v[174:175], v[174:175], v[176:177] op_sel_hi:[1,0]
    v_pk_mul_f32 v[188:189], v[188:189], v[220:221] op_sel_hi:[1,0]
    v_pk_mul_f32 v[190:191], v[190:191], v[220:221] op_sel_hi:[1,0]
    v_cvt_pk_bf16_f32 v122, v110, v111
    v_cvt_pk_bf16_f32 v123, v112, v113
    buffer_store_dwordx2 v[122:123], v24, s[40:43], s54 offen sc1
    s_add_u32 s54, s54, 32768
    v_cvt_pk_bf16_f32 v168, v126, v127
    v_cvt_pk_bf16_f32 v169, v128, v129
    buffer_store_dwordx2 v[168:169], v24, s[40:43], s55 offen sc1
    s_add_u32 s55, s55, 32768
    v_cvt_pk_bf16_f32 v184, v172, v173
    v_cvt_pk_bf16_f32 v185, v174, v175
    buffer_store_dwordx2 v[184:185], v24, s[40:43], s54 offen sc1
    s_add_u32 s54, s54, 32768
    v_cvt_pk_bf16_f32 v228, v188, v189
    v_cvt_pk_bf16_f32 v229, v190, v191
    buffer_store_dwordx2 v[228:229], v24, s[40:43], s55 offen sc1
    s_add_u32 s55, s55, 32768
    s_waitcnt vmcnt(6)
    ds_read_b64_tr_b16 a[40:41], v18 offset:10240
    ds_read_b64_tr_b16 a[42:43], v18 offset:11264
    ds_read_b64_tr_b16 a[44:45], v19 offset:10240
    ds_read_b64_tr_b16 a[46:47], v19 offset:11264
    ds_read_b64_tr_b16 a[48:49], v18 offset:12288
    ds_read_b64_tr_b16 a[50:51], v18 offset:13312
    ds_read_b64_tr_b16 a[52:53], v19 offset:12288
    ds_read_b64_tr_b16 a[54:55], v19 offset:13312
    s_waitcnt lgkmcnt(4)
    ds_read_b64_tr_b16 a[56:57], v18 offset:14336
    ds_read_b64_tr_b16 a[58:59], v18 offset:15360
    ds_read_b64_tr_b16 a[60:61], v19 offset:14336
    ds_read_b64_tr_b16 a[62:63], v19 offset:15360
    ds_read_b64_tr_b16 a[64:65], v18 offset:16384
    ds_read_b64_tr_b16 a[66:67], v18 offset:17408
    ds_read_b64_tr_b16 a[68:69], v19 offset:16384
    ds_read_b64_tr_b16 a[70:71], v19 offset:17408
    s_waitcnt lgkmcnt(4)
    ds_read_b64_tr_b16 a[72:73], v18 offset:18432
    ds_read_b64_tr_b16 a[74:75], v18 offset:19456
    ds_read_b64_tr_b16 a[76:77], v19 offset:18432
    ds_read_b64_tr_b16 a[78:79], v19 offset:19456
    s_waitcnt lgkmcnt(0)
    s_add_u32 m0, s58, 22528
    s_add_u32 s48, s67, 65536
    buffer_load_dwordx4 v9, s[36:39], s67 offen lds
    s_add_u32 m0, s58, 23552
    s_cmp_eq_u32 s48, s61
    buffer_load_dwordx4 v27, s[36:39], s67 offen lds
    s_cselect_b32 s67, s66, s48
    s_add_u32 m0, s58, 0
    s_add_u32 s48, s67, 65536
    buffer_load_dwordx4 v9, s[36:39], s67 offen lds
    s_add_u32 m0, s58, 1024
    s_cmp_eq_u32 s48, s61
    buffer_load_dwordx4 v27, s[36:39], s67 offen lds
    s_cselect_b32 s67, s66, s48
    s_add_u32 m0, s58, 2048
    s_add_u32 s48, s67, 65536
    buffer_load_dwordx4 v9, s[36:39], s67 offen lds
    s_add_u32 m0, s58, 3072
    s_cmp_eq_u32 s48, s61
    buffer_load_dwordx4 v27, s[36:39], s67 offen lds
    s_cselect_b32 s67, s66, s48
    s_add_u32 m0, s58, 4096
    s_add_u32 s48, s67, 65536
    buffer_load_dwordx4 v9, s[36:39], s67 offen lds
    s_add_u32 m0, s58, 5120
    s_cmp_eq_u32 s48, s61
    buffer_load_dwordx4 v27, s[36:39], s67 offen lds
    s_cselect_b32 s67, s66, s48
    s_add_u32 m0, s58, 6144
    s_add_u32 s48, s67, 65536
    buffer_load_dwordx4 v9, s[36:39], s67 offen lds
    s_add_u32 m0, s58, 7168
    s_cmp_eq_u32 s48, s61
    buffer_load_dwordx4 v27, s[36:39], s67 offen lds
    s_cselect_b32 s67, s66, s48
    s_nop 1
    v_mfma_f32_16x16x16_bf16 v[110:113], v[152:153], v[100:101], 0
    v_mfma_f32_16x16x16_bf16 v[114:117], v[154:155], v[100:101], 0
    v_mfma_f32_16x16x16_bf16 v[126:129], v[154:155], v[102:103], 0
    v_mfma_f32_16x16x16_bf16 v[130:133], v[156:157], v[102:103], 0
    v_mfma_f32_16x16x16_bf16 v[172:175], v[156:157], v[104:105], 0
    v_mfma_f32_16x16x16_bf16 v[176:179], v[158:159], v[104:105], 0
    v_mfma_f32_16x16x16_bf16 v[188:191], v[158:159], v[106:107], 0
    v_mfma_f32_16x16x16_bf16 v[220:223], v[160:161], v[106:107], 0
    v_mfma_f32_16x16x16_bf16 v[232:235], v[160:161], v[108:109], 0
    v_mfma_f32_16x16x16_bf16 v[236:239], v[162:163], v[108:109], 0
    s_nop 1
    v_pk_fma_f32 v[110:111], v[110:111], v[54:55], v[60:61] op_sel:[0,1,0] op_sel_hi:[1,1,1]
    v_pk_fma_f32 v[112:113], v[112:113], v[54:55], v[62:63] op_sel:[0,1,0] op_sel_hi:[1,1,1]
    v_pk_fma_f32 v[114:115], v[114:115], v[54:55], v[64:65] op_sel:[0,1,0] op_sel_hi:[1,1,1]
    v_pk_fma_f32 v[116:117], v[116:117], v[54:55], v[66:67] op_sel:[0,1,0] op_sel_hi:[1,1,1]
    v_pk_fma_f32 v[126:127], v[126:127], v[56:57], v[60:61] op_sel:[0,0,0] op_sel_hi:[1,0,1]
    v_pk_fma_f32 v[128:129], v[128:129], v[56:57], v[62:63] op_sel:[0,0,0] op_sel_hi:[1,0,1]
    v_pk_fma_f32 v[130:131], v[130:131], v[56:57], v[64:65] op_sel:[0,0,0] op_sel_hi:[1,0,1]
    v_pk_fma_f32 v[132:133], v[132:133], v[56:57], v[66:67] op_sel:[0,0,0] op_sel_hi:[1,0,1]
    v_pk_fma_f32 v[172:173], v[172:173], v[56:57], v[60:61] op_sel:[0,1,0] op_sel_hi:[1,1,1]
    v_pk_fma_f32 v[174:175], v[174:175], v[56:57], v[62:63] op_sel:[0,1,0] op_sel_hi:[1,1,1]
    v_pk_fma_f32 v[176:177], v[176:177], v[56:57], v[64:65] op_sel:[0,1,0] op_sel_hi:[1,1,1]
    v_pk_fma_f32 v[178:179], v[178:179], v[56:57], v[66:67] op_sel:[0,1,0] op_sel_hi:[1,1,1]
    v_pk_fma_f32 v[188:189], v[188:189], v[58:59], v[60:61] op_sel:[0,0,0] op_sel_hi:[1,0,1]
    v_pk_fma_f32 v[190:191], v[190:191], v[58:59], v[62:63] op_sel:[0,0,0] op_sel_hi:[1,0,1]
    v_pk_fma_f32 v[220:221], v[220:221], v[58:59], v[64:65] op_sel:[0,0,0] op_sel_hi:[1,0,1]
    v_pk_fma_f32 v[222:223], v[222:223], v[58:59], v[66:67] op_sel:[0,0,0] op_sel_hi:[1,0,1]
    v_pk_fma_f32 v[232:233], v[232:233], v[58:59], v[60:61] op_sel:[0,1,0] op_sel_hi:[1,1,1]
    v_pk_fma_f32 v[234:235], v[234:235], v[58:59], v[62:63] op_sel:[0,1,0] op_sel_hi:[1,1,1]
    v_pk_fma_f32 v[236:237], v[236:237], v[58:59], v[64:65] op_sel:[0,1,0] op_sel_hi:[1,1,1]
    v_pk_fma_f32 v[238:239], v[238:239], v[58:59], v[66:67] op_sel:[0,1,0] op_sel_hi:[1,1,1]
    v_max3_f32 v118, v110, v111, v112
    v_max3_f32 v119, v114, v115, v116
    v_max3_f32 v118, v118, v113, v117
    v_max_f32 v118, v118, v119
    v_max3_f32 v164, v126, v127, v128
    v_max3_f32 v165, v130, v131, v132
    v_max3_f32 v164, v164, v129, v133
    v_max_f32 v164, v164, v165
    v_max3_f32 v180, v172, v173, v174
    v_max3_f32 v181, v176, v177, v178
    v_max3_f32 v180, v180, v175, v179
    v_max_f32 v180, v180, v181
    v_max3_f32 v224, v188, v189, v190
    v_max3_f32 v225, v220, v221, v222
    v_max3_f32 v224, v224, v191, v223
    v_max_f32 v224, v224, v225
    v_max3_f32 v240, v232, v233, v234
    v_max3_f32 v241, v236, v237, v238
    v_max3_f32 v240, v240, v235, v239
    v_max_f32 v240, v240, v241
    v_mov_b32 v119, v118
    v_mov_b32 v165, v164
    v_mov_b32 v181, v180
    v_mov_b32 v225, v224
    v_mov_b32 v241, v240
    v_permlane16_swap_b32 v118, v119
    v_permlane16_swap_b32 v164, v165
    v_permlane16_swap_b32 v180, v181
    v_permlane16_swap_b32 v224, v225
    v_permlane16_swap_b32 v240, v241
    v_max_f32 v118, v118, v119
    v_max_f32 v164, v164, v165
    v_max_f32 v180, v180, v181
    v_max_f32 v224, v224, v225
    v_max_f32 v240, v240, v241
    v_mov_b32 v119, v118
    v_mov_b32 v165, v164
    v_mov_b32 v181, v180
    v_mov_b32 v225, v224
    v_mov_b32 v241, v240
    v_permlane32_swap_b32 v118, v119
    v_permlane32_swap_b32 v164, v165
    v_permlane32_swap_b32 v180, v181
    v_permlane32_swap_b32 v224, v225
    v_permlane32_swap_b32 v240, v241
    v_max_f32 v118, v118, v119
    v_max_f32 v164, v164, v165
    v_max_f32 v180, v180, v181
    v_max_f32 v224, v224, v225
    v_max_f32 v240, v240, v241
    v_pk_add_f32 v[110:111], v[110:111], v[118:119] op_sel_hi:[1,0] neg_lo:[0,1] neg_hi:[0,1]
    v_pk_add_f32 v[112:113], v[112:113], v[118:119] op_sel_hi:[1,0] neg_lo:[0,1] neg_hi:[0,1]
    v_pk_add_f32 v[114:115], v[114:115], v[118:119] op_sel_hi:[1,0] neg_lo:[0,1] neg_hi:[0,1]
    v_pk_add_f32 v[116:117], v[116:117], v[118:119] op_sel_hi:[1,0] neg_lo:[0,1] neg_hi:[0,1]
    v_pk_add_f32 v[126:127], v[126:127], v[164:165] op_sel_hi:[1,0] neg_lo:[0,1] neg_hi:[0,1]
    v_pk_add_f32 v[128:129], v[128:129], v[164:165] op_sel_hi:[1,0] neg_lo:[0,1] neg_hi:[0,1]
    v_pk_add_f32 v[130:131], v[130:131], v[164:165] op_sel_hi:[1,0] neg_lo:[0,1] neg_hi:[0,1]
    v_pk_add_f32 v[132:133], v[132:133], v[164:165] op_sel_hi:[1,0] neg_lo:[0,1] neg_hi:[0,1]
    v_pk_add_f32 v[172:173], v[172:173], v[180:181] op_sel_hi:[1,0] neg_lo:[0,1] neg_hi:[0,1]
    v_pk_add_f32 v[174:175], v[174:175], v[180:181] op_sel_hi:[1,0] neg_lo:[0,1] neg_hi:[0,1]
    v_pk_add_f32 v[176:177], v[176:177], v[180:181] op_sel_hi:[1,0] neg_lo:[0,1] neg_hi:[0,1]
    v_pk_add_f32 v[178:179], v[178:179], v[180:181] op_sel_hi:[1,0] neg_lo:[0,1] neg_hi:[0,1]
    v_pk_add_f32 v[188:189], v[188:189], v[224:225] op_sel_hi:[1,0] neg_lo:[0,1] neg_hi:[0,1]
    v_pk_add_f32 v[190:191], v[190:191], v[224:225] op_sel_hi:[1,0] neg_lo:[0,1] neg_hi:[0,1]
    v_pk_add_f32 v[220:221], v[220:221], v[224:225] op_sel_hi:[1,0] neg_lo:[0,1] neg_hi:[0,1]
    v_pk_add_f32 v[222:223], v[222:223], v[224:225] op_sel_hi:[1,0] neg_lo:[0,1] neg_hi:[0,1]
    v_pk_add_f32 v[232:233], v[232:233], v[240:241] op_sel_hi:[1,0] neg_lo:[0,1] neg_hi:[0,1]
    v_pk_add_f32 v[234:235], v[234:235], v[240:241] op_sel_hi:[1,0] neg_lo:[0,1] neg_hi:[0,1]
    v_pk_add_f32 v[236:237], v[236:237], v[240:241] op_sel_hi:[1,0] neg_lo:[0,1] neg_hi:[0,1]
    v_pk_add_f32 v[238:239], v[238:239], v[240:241] op_sel_hi:[1,0] neg_lo:[0,1] neg_hi:[0,1]
    v_exp_f32 v110, v110
    v_exp_f32 v111, v111
    v_exp_f32 v112, v112
    v_exp_f32 v113, v113
    v_exp_f32 v114, v114
    v_exp_f32 v115, v115
    v_exp_f32 v116, v116
    v_exp_f32 v117, v117
    v_exp_f32 v126, v126
    v_exp_f32 v127, v127
    v_exp_f32 v128, v128
    v_exp_f32 v129, v129
    v_exp_f32 v130, v130
    v_exp_f32 v131, v131
    v_exp_f32 v132, v132
    v_exp_f32 v133, v133
    v_exp_f32 v172, v172
    v_exp_f32 v173, v173
    v_exp_f32 v174, v174
    v_exp_f32 v175, v175
    v_exp_f32 v176, v176
    v_exp_f32 v177, v177
    v_exp_f32 v178, v178
    v_exp_f32 v179, v179
    v_exp_f32 v188, v188
    v_exp_f32 v189, v189
    v_exp_f32 v190, v190
    v_exp_f32 v191, v191
    v_exp_f32 v220, v220
    v_exp_f32 v221, v221
    v_exp_f32 v222, v222
    v_exp_f32 v223, v223
    v_exp_f32 v232, v232
    v_exp_f32 v233, v233
    v_exp_f32 v234, v234
    v_exp_f32 v235, v235
    v_exp_f32 v236, v236
    v_exp_f32 v237, v237
    v_exp_f32 v238, v238
    v_exp_f32 v239, v239
    v_cvt_pk_bf16_f32 v118, v110, v111
    v_cvt_pk_bf16_f32 v119, v112, v113
    v_cvt_pk_bf16_f32 v120, v114, v115
    v_cvt_pk_bf16_f32 v121, v116, v117
    v_cvt_pk_bf16_f32 v164, v126, v127
    v_cvt_pk_bf16_f32 v165, v128, v129
    v_cvt_pk_bf16_f32 v166, v130, v131
    v_cvt_pk_bf16_f32 v167, v132, v133
    v_cvt_pk_bf16_f32 v180, v172, v173
    v_cvt_pk_bf16_f32 v181, v174, v175
    v_cvt_pk_bf16_f32 v182, v176, v177
    v_cvt_pk_bf16_f32 v183, v178, v179
    v_cvt_pk_bf16_f32 v224, v188, v189
    v_cvt_pk_bf16_f32 v225, v190, v191
    v_cvt_pk_bf16_f32 v226, v220, v221
    v_cvt_pk_bf16_f32 v227, v222, v223
    v_cvt_pk_bf16_f32 v240, v232, v233
    v_cvt_pk_bf16_f32 v241, v234, v235
    v_cvt_pk_bf16_f32 v242, v236, v237
    v_cvt_pk_bf16_f32 v243, v238, v239
    s_nop 1
    v_mfma_f32_16x16x32_bf16 v[114:117], v[28:31], v[118:121], 0
    v_mfma_f32_16x16x32_bf16 v[110:113], v[208:211], v[118:121], 0
    v_mfma_f32_16x16x32_bf16 v[130:133], v[28:31], v[164:167], 0
    v_mfma_f32_16x16x32_bf16 v[126:129], v[210:213], v[164:167], 0
    v_mfma_f32_16x16x32_bf16 v[176:179], v[28:31], v[180:183], 0
    v_mfma_f32_16x16x32_bf16 v[172:175], v[212:215], v[180:183], 0
    v_mfma_f32_16x16x32_bf16 v[220:223], v[28:31], v[224:227], 0
    v_mfma_f32_16x16x32_bf16 v[188:191], v[214:217], v[224:227], 0
    v_mfma_f32_16x16x32_bf16 v[236:239], v[28:31], v[240:243], 0
    v_mfma_f32_16x16x32_bf16 v[232:235], v[216:219], v[240:243], 0
    s_nop 3
    v_rcp_f32 v114, v114
    v_rcp_f32 v130, v130
    v_rcp_f32 v176, v176
    v_rcp_f32 v220, v220
    v_rcp_f32 v236, v236
    v_pk_mul_f32 v[110:111], v[110:111], v[114:115] op_sel_hi:[1,0]
    v_pk_mul_f32 v[112:113], v[112:113], v[114:115] op_sel_hi:[1,0]
    v_pk_mul_f32 v[126:127], v[126:127], v[130:131] op_sel_hi:[1,0]
    v_pk_mul_f32 v[128:129], v[128:129], v[130:131] op_sel_hi:[1,0]
    v_pk_mul_f32 v[172:173], v[172:173], v[176:177] op_sel_hi:[1,0]
    v_pk_mul_f32 v[174:175], v[174:175], v[176:177] op_sel_hi:[1,0]
    v_pk_mul_f32 v[188:189], v[188:189], v[220:221] op_sel_hi:[1,0]
    v_pk_mul_f32 v[190:191], v[190:191], v[220:221] op_sel_hi:[1,0]
    v_pk_mul_f32 v[232:233], v[232:233], v[236:237] op_sel_hi:[1,0]
    v_pk_mul_f32 v[234:235], v[234:235], v[236:237] op_sel_hi:[1,0]
    v_cvt_pk_bf16_f32 v122, v110, v111
    v_cvt_pk_bf16_f32 v123, v112, v113
    buffer_store_dwordx2 v[122:123], v24, s[40:43], s54 offen sc1
    s_add_u32 s54, s54, 32768
    v_cvt_pk_bf16_f32 v168, v126, v127
    v_cvt_pk_bf16_f32 v169, v128, v129
    buffer_store_dwordx2 v[168:169], v24, s[40:43], s55 offen sc1
    s_add_u32 s55, s55, 32768
    v_cvt_pk_bf16_f32 v184, v172, v173
    v_cvt_pk_bf16_f32 v185, v174, v175
    buffer_store_dwordx2 v[184:185], v24, s[40:43], s54 offen sc1
    s_add_u32 s54, s54, 32768
    v_cvt_pk_bf16_f32 v228, v188, v189
    v_cvt_pk_bf16_f32 v229, v190, v191
    buffer_store_dwordx2 v[228:229], v24, s[40:43], s55 offen sc1
    s_add_u32 s55, s55, 32768
    v_cvt_pk_bf16_f32 v244, v232, v233
    v_cvt_pk_bf16_f32 v245, v234, v235
    buffer_store_dwordx2 v[244:245], v24, s[40:43], s54 offen sc1
    s_add_u32 s54, s54, 32768
    s_lshl_b32 s48, s76, 3
    s_add_u32 s48, s48, s77
    s_mul_i32 s48, s48, 64
    s_add_u32 s73, s48, 0x705000
    s_add_u32 m0, s58, 8192
    s_add_u32 s48, s67, 65536
    buffer_load_dwordx4 v9, s[36:39], s67 offen lds
    s_add_u32 m0, s58, 9216
    s_cmp_eq_u32 s48, s61
    buffer_load_dwordx4 v27, s[36:39], s67 offen lds
    s_cselect_b32 s67, s66, s48
    s_add_u32 m0, s58, 10240
    s_add_u32 s48, s67, 65536
    buffer_load_dwordx4 v9, s[36:39], s67 offen lds
    s_add_u32 m0, s58, 11264
    s_cmp_eq_u32 s48, s61
    buffer_load_dwordx4 v27, s[36:39], s67 offen lds
    s_cselect_b32 s67, s66, s48
    s_add_u32 m0, s58, 12288
    s_add_u32 s48, s67, 65536
    buffer_load_dwordx4 v9, s[36:39], s67 offen lds
    s_add_u32 m0, s58, 13312
    s_cmp_eq_u32 s48, s61
    buffer_load_dwordx4 v27, s[36:39], s67 offen lds
    s_cselect_b32 s67, s66, s48
    s_add_u32 m0, s58, 14336
    s_add_u32 s48, s67, 65536
    buffer_load_dwordx4 v9, s[36:39], s67 offen lds
    s_add_u32 m0, s58, 15360
    s_cmp_eq_u32 s48, s61
    buffer_load_dwordx4 v27, s[36:39], s67 offen lds
    s_cselect_b32 s67, s66, s48
    s_add_u32 m0, s58, 16384
    s_add_u32 s48, s67, 65536
    buffer_load_dwordx4 v9, s[36:39], s67 offen lds
    s_add_u32 m0, s58, 17408
    s_cmp_eq_u32 s48, s61
    buffer_load_dwordx4 v27, s[36:39], s67 offen lds
    s_cselect_b32 s67, s66, s48
    s_add_u32 m0, s58, 18432
    s_add_u32 s48, s67, 65536
    buffer_load_dwordx4 v9, s[36:39], s67 offen lds
    s_add_u32 m0, s58, 19456
    s_cmp_eq_u32 s48, s61
    buffer_load_dwordx4 v27, s[36:39], s67 offen lds
    s_cselect_b32 s67, s66, s48
    s_waitcnt vmcnt(12)
    s_barrier
    s_cmp_lg_u32 s26, 0
    s_cbranch_scc1 Lf_21
    v_mov_b32 v4, s74
    v_mov_b32 v5, s75
    v_mov_b32 v2, 0
    s_mov_b64 exec, 1
    buffer_store_dwordx2 v[4:5], v2, s[28:31], s73 offen sc1
    s_mov_b64 exec, -1
Lf_21:
    s_mov_b32 s40, s4
    s_and_b32 s41, s5, 0xffff
    s_mov_b32 s42, 0x200000
    s_mov_b32 s43, 0x20000
    s_mov_b32 s44, s18
    s_and_b32 s45, s19, 0xffff
    s_mov_b32 s46, 0x1000
    s_mov_b32 s47, 0x20000
    v_and_b32 v2, 31, v1
    v_lshlrev_b32 v3, 10, v2
    v_lshrrev_b32 v4, 5, v1
    v_lshl_add_u32 v8, v4, 3, v3
    s_lshl_b32 s70, s78, 6
    s_lshl_b32 s48, s57, 5
    s_add_u32 s70, s70, s48
    s_lshl_b32 s71, s70, 10
    s_lshl_b32 s48, s79, 7
    s_add_u32 s71, s71, s48
    s_lshl_b32 s48, s56, 6
    s_add_u32 s71, s71, s48
    buffer_load_dwordx2 v[40:41], v8, s[40:43], s71 offen offset:0
    buffer_load_dwordx2 v[42:43], v8, s[40:43], s71 offen offset:16
    buffer_load_dwordx2 v[44:45], v8, s[40:43], s71 offen offset:32
    buffer_load_dwordx2 v[46:47], v8, s[40:43], s71 offen offset:48
    v_lshlrev_b32 v2, 1, v2
    s_lshl_b32 s72, s70, 1
    buffer_load_ushort v48, v2, s[44:47], s72 offen
    s_mul_i32 s48, s26, 352
    s_lshr_b32 s49, s48, 6
    s_add_u32 s50, s48, 351
    s_lshr_b32 s50, s50, 6
    s_min_u32 s50, s50, 21
    v_add_u32 v2, s49, v1
    v_min_u32 v2, s50, v2
    v_lshlrev_b32 v2, 3, v2
    v_add_u32 v2, s79, v2
    v_mul_u32_u24 v2, 64, v2
    v_add_u32 v20, 0x702000, v2
    s_lshl_b32 s48, s78, 6
    s_mul_hi_u32 s49, s48, 0x13b13b2
    s_add_u32 s48, s48, 63
    s_mul_hi_u32 s50, s48, 0x13b13b2
    v_and_b32 v2, 1, v1
    v_bfe_u32 v3, v1, 1, 1
    v_mov_b32 v4, s49
    v_mov_b32 v5, s50
    v_cmp_eq_u32 vcc, 1, v3
    s_nop 1
    v_cndmask_b32 v4, v4, v5, vcc
    v_lshlrev_b32 v4, 3, v4
    v_add_u32 v4, v4, v2
    s_lshl_b32 s48, s26, 1
    v_add_u32 v4, s48, v4
    v_mul_u32_u24 v4, 64, v4
    v_add_u32 v21, 0x705000, v4
    s_lshl_b32 s59, s64, 10
    s_and_b32 s53, s65, 7
    s_lshl_b32 s53, s53, 10
    v_add_u32 v22, s62, v11
    v_add_u32 v23, s63, v11
    v_add_u32 v25, s68, v11
    v_add_u32 v26, s69, v11
    ds_read_b64_tr_b16 a[80:81], v18 offset:20480
    ds_read_b64_tr_b16 a[82:83], v18 offset:21504
    ds_read_b64_tr_b16 a[84:85], v19 offset:20480
    ds_read_b64_tr_b16 a[86:87], v19 offset:21504
    ds_read_b64_tr_b16 a[88:89], v18 offset:22528
    ds_read_b64_tr_b16 a[90:91], v18 offset:23552
    ds_read_b64_tr_b16 a[92:93], v19 offset:22528
    ds_read_b64_tr_b16 a[94:95], v19 offset:23552
    s_waitcnt lgkmcnt(4)
    ds_read_b64_tr_b16 a[96:97], v18 offset:0
    ds_read_b64_tr_b16 a[98:99], v18 offset:1024
    ds_read_b64_tr_b16 a[100:101], v19 offset:0
    ds_read_b64_tr_b16 a[102:103], v19 offset:1024
    ds_read_b64_tr_b16 a[104:105], v18 offset:2048
    ds_read_b64_tr_b16 a[106:107], v18 offset:3072
    ds_read_b64_tr_b16 a[108:109], v19 offset:2048
    ds_read_b64_tr_b16 a[110:111], v19 offset:3072
    s_waitcnt lgkmcnt(4)
    s_waitcnt lgkmcnt(0)
    s_add_u32 s48, s65, 0
    s_and_b32 s48, s48, 7
    s_lshl_b32 s48, s48, 14
    s_add_u32 m0, s58, 20480
    s_add_u32 s48, s48, s60
    buffer_load_dwordx4 v10, s[32:35], s48 offen lds
    s_add_u32 m0, s58, 21504
    s_add_u32 s48, s48, 8192
    buffer_load_dwordx4 v10, s[32:35], s48 offen lds
    s_add_u32 s48, s65, 1
    s_and_b32 s48, s48, 7
    s_lshl_b32 s48, s48, 14
    s_add_u32 m0, s58, 22528
    s_add_u32 s48, s48, s60
    buffer_load_dwordx4 v10, s[32:35], s48 offen lds
    s_add_u32 m0, s58, 23552
    s_add_u32 s48, s48, 8192
    buffer_load_dwordx4 v10, s[32:35], s48 offen lds
    s_add_u32 s48, s65, 2
    s_and_b32 s48, s48, 7
    s_lshl_b32 s48, s48, 14
    s_add_u32 m0, s58, 0
    s_add_u32 s48, s48, s60
    buffer_load_dwordx4 v10, s[32:35], s48 offen lds
    s_add_u32 m0, s58, 1024
    s_add_u32 s48, s48, 8192
    buffer_load_dwordx4 v10, s[32:35], s48 offen lds
    s_add_u32 s48, s65, 3
    s_and_b32 s48, s48, 7
    s_lshl_b32 s48, s48, 14
    s_add_u32 m0, s58, 2048
    s_add_u32 s48, s48, s60
    buffer_load_dwordx4 v10, s[32:35], s48 offen lds
    s_add_u32 m0, s58, 3072
    s_add_u32 s48, s48, 8192
    buffer_load_dwordx4 v10, s[32:35], s48 offen lds
    ds_read_b64_tr_b16 a[112:113], v18 offset:4096
    ds_read_b64_tr_b16 a[114:115], v18 offset:5120
    ds_read_b64_tr_b16 a[116:117], v19 offset:4096
    ds_read_b64_tr_b16 a[118:119], v19 offset:5120
    ds_read_b64_tr_b16 a[120:121], v18 offset:6144
    ds_read_b64_tr_b16 a[122:123], v18 offset:7168
    ds_read_b64_tr_b16 a[124:125], v19 offset:6144
    ds_read_b64_tr_b16 a[126:127], v19 offset:7168
    s_waitcnt lgkmcnt(4)
    s_waitcnt lgkmcnt(0)
    s_add_u32 s48, s65, 4
    s_and_b32 s48, s48, 7
    s_lshl_b32 s48, s48, 14
    s_add_u32 m0, s58, 4096
    s_add_u32 s48, s48, s60
    buffer_load_dwordx4 v10, s[32:35], s48 offen lds
    s_add_u32 m0, s58, 5120
    s_add_u32 s48, s48, 8192
    buffer_load_dwordx4 v10, s[32:35], s48 offen lds
    s_add_u32 s48, s65, 5
    s_and_b32 s48, s48, 7
    s_lshl_b32 s48, s48, 14
    s_add_u32 m0, s58, 6144
    s_add_u32 s48, s48, s60
    buffer_load_dwordx4 v10, s[32:35], s48 offen lds
    s_add_u32 m0, s58, 7168
    s_add_u32 s48, s48, 8192
    buffer_load_dwordx4 v10, s[32:35], s48 offen lds
    buffer_load_dwordx2 v[30:31], v20, s[28:31], 0 offen sc1
    s_waitcnt vmcnt(22)
    ds_read_b64_tr_b16 a[128:129], v18 offset:8192
    ds_read_b64_tr_b16 a[130:131], v18 offset:9216
    ds_read_b64_tr_b16 a[132:133], v19 offset:8192
    ds_read_b64_tr_b16 a[134:135], v19 offset:9216
    ds_read_b64_tr_b16 a[136:137], v18 offset:10240
    ds_read_b64_tr_b16 a[138:139], v18 offset:11264
    ds_read_b64_tr_b16 a[140:141], v19 offset:10240
    ds_read_b64_tr_b16 a[142:143], v19 offset:11264
    s_waitcnt lgkmcnt(4)
    ds_read_b64_tr_b16 a[144:145], v18 offset:12288
    ds_read_b64_tr_b16 a[146:147], v18 offset:13312
    ds_read_b64_tr_b16 a[148:149], v19 offset:12288
    ds_read_b64_tr_b16 a[150:151], v19 offset:13312
    ds_read_b64_tr_b16 a[152:153], v18 offset:14336
    ds_read_b64_tr_b16 a[154:155], v18 offset:15360
    ds_read_b64_tr_b16 a[156:157], v19 offset:14336
    ds_read_b64_tr_b16 a[158:159], v19 offset:15360
    s_waitcnt lgkmcnt(4)
    s_waitcnt lgkmcnt(0)
    s_add_u32 s48, s65, 6
    s_and_b32 s48, s48, 7
    s_lshl_b32 s48, s48, 14
    s_add_u32 m0, s58, 8192
    s_add_u32 s48, s48, s60
    buffer_load_dwordx4 v10, s[32:35], s48 offen lds
    s_add_u32 m0, s58, 9216
    s_add_u32 s48, s48, 8192
    buffer_load_dwordx4 v10, s[32:35], s48 offen lds
    s_add_u32 s48, s65, 7
    s_and_b32 s48, s48, 7
    s_lshl_b32 s48, s48, 14
    s_add_u32 m0, s58, 10240
    s_add_u32 s48, s48, s60
    buffer_load_dwordx4 v10, s[32:35], s48 offen lds
    s_add_u32 m0, s58, 11264
    s_add_u32 s48, s48, 8192
    buffer_load_dwordx4 v10, s[32:35], s48 offen lds
L_final:
    s_waitcnt vmcnt(4)
    v_cmp_ne_u32 vcc, s74, v30
    v_cmp_ne_u32 s[50:51], s75, v31
    s_or_b64 vcc, vcc, s[50:51]
    s_cbranch_vccz Lok_22
    s_mov_b32 s48, 0
Lp_23:
    buffer_load_dwordx2 v[4:5], v20, s[28:31], 0 offen sc1
    s_add_u32 s48, s48, 1
    s_waitcnt vmcnt(0)
    v_cmp_ne_u32 vcc, s74, v4
    v_cmp_ne_u32 s[50:51], s75, v5
    s_or_b64 vcc, vcc, s[50:51]
    s_cbranch_vccz Ld_24
    s_cmp_lt_u32 s48, 200000
    s_cbranch_scc0 Ld_24
    s_sleep 1
    s_branch Lp_23
Ld_24:
Lok_22:
    buffer_load_dwordx4 v[128:131], v25, s[28:31], s59 offen
    buffer_load_dwordx4 v[132:135], v26, s[28:31], s59 offen
    s_add_u32 s59, s59, 1024
    s_cmp_eq_u32 s59, 22528
    s_cselect_b32 s59, 0, s59
    buffer_load_dwordx4 v[136:139], v25, s[28:31], s59 offen
    buffer_load_dwordx4 v[140:143], v26, s[28:31], s59 offen
    s_add_u32 s59, s59, 1024
    s_cmp_eq_u32 s59, 22528
    s_cselect_b32 s59, 0, s59
    buffer_load_dwordx4 v[144:147], v25, s[28:31], s59 offen
    buffer_load_dwordx4 v[148:151], v26, s[28:31], s59 offen
    s_add_u32 s59, s59, 1024
    s_cmp_eq_u32 s59, 22528
    s_cselect_b32 s59, 0, s59
    buffer_load_dwordx4 v[152:155], v25, s[28:31], s59 offen
    buffer_load_dwordx4 v[156:159], v26, s[28:31], s59 offen
    s_add_u32 s59, s59, 1024
    s_cmp_eq_u32 s59, 22528
    s_cselect_b32 s59, 0, s59
    buffer_load_dwordx4 v[160:163], v25, s[28:31], s59 offen
    buffer_load_dwordx4 v[164:167], v26, s[28:31], s59 offen
    s_add_u32 s59, s59, 1024
    s_cmp_eq_u32 s59, 22528
    s_cselect_b32 s59, 0, s59
    buffer_load_dwordx4 v[168:171], v25, s[28:31], s59 offen
    buffer_load_dwordx4 v[172:175], v26, s[28:31], s59 offen
    s_add_u32 s59, s59, 1024
    s_cmp_eq_u32 s59, 22528
    s_cselect_b32 s59, 0, s59
    buffer_load_dwordx4 v[176:179], v25, s[28:31], s59 offen
    buffer_load_dwordx4 v[180:183], v26, s[28:31], s59 offen
    s_add_u32 s59, s59, 1024
    s_cmp_eq_u32 s59, 22528
    s_cselect_b32 s59, 0, s59
    buffer_load_dwordx4 v[184:187], v25, s[28:31], s59 offen
    buffer_load_dwordx4 v[188:191], v26, s[28:31], s59 offen
    s_add_u32 s59, s59, 1024
    s_cmp_eq_u32 s59, 22528
    s_cselect_b32 s59, 0, s59
    ds_read_b64_tr_b16 a[160:161], v18 offset:16384
    ds_read_b64_tr_b16 a[162:163], v18 offset:17408
    ds_read_b64_tr_b16 a[164:165], v19 offset:16384
    ds_read_b64_tr_b16 a[166:167], v19 offset:17408
    s_waitcnt vmcnt(14)
    v_mfma_f32_32x32x16_bf16 v[64:79], v[128:131], a[0:3], 0
    v_mfma_f32_32x32x16_bf16 v[80:95], v[128:131], a[4:7], 0
    buffer_load_dwordx4 v[128:131], v25, s[28:31], s59 offen
    v_mfma_f32_32x32x16_bf16 v[96:111], v[132:135], a[0:3], 0
    v_mfma_f32_32x32x16_bf16 v[112:127], v[132:135], a[4:7], 0
    buffer_load_dwordx4 v[132:135], v26, s[28:31], s59 offen
    s_add_u32 s59, s59, 1024
    s_cmp_eq_u32 s59, 22528
    s_cselect_b32 s59, 0, s59
    s_waitcnt lgkmcnt(0)
    ds_read_b64_tr_b16 a[168:169], v18 offset:18432
    ds_read_b64_tr_b16 a[170:171], v18 offset:19456
    ds_read_b64_tr_b16 a[172:173], v19 offset:18432
    ds_read_b64_tr_b16 a[174:175], v19 offset:19456
    s_waitcnt vmcnt(14)
    v_mfma_f32_32x32x16_bf16 v[64:79], v[136:139], a[8:11], v[64:79]
    v_mfma_f32_32x32x16_bf16 v[80:95], v[136:139], a[12:15], v[80:95]
    buffer_load_dwordx4 v[136:139], v25, s[28:31], s59 offen
    v_mfma_f32_32x32x16_bf16 v[96:111], v[140:143], a[8:11], v[96:111]
    v_mfma_f32_32x32x16_bf16 v[112:127], v[140:143], a[12:15], v[112:127]
    buffer_load_dwordx4 v[140:143], v26, s[28:31], s59 offen
    s_add_u32 s59, s59, 1024
    s_cmp_eq_u32 s59, 22528
    s_cselect_b32 s59, 0, s59
    s_waitcnt lgkmcnt(0)
    ds_read_b64_tr_b16 a[176:177], v12 offset:20480
    ds_read_b64_tr_b16 a[178:179], v12 offset:20992
    ds_read_b64_tr_b16 a[180:181], v13 offset:20480
    ds_read_b64_tr_b16 a[182:183], v13 offset:20992
    s_waitcnt vmcnt(14)
    v_mfma_f32_32x32x16_bf16 v[64:79], v[144:147], a[16:19], v[64:79]
    v_mfma_f32_32x32x16_bf16 v[80:95], v[144:147], a[20:23], v[80:95]
    buffer_load_dwordx4 v[144:147], v25, s[28:31], s59 offen
    v_mfma_f32_32x32x16_bf16 v[96:111], v[148:151], a[16:19], v[96:111]
    v_mfma_f32_32x32x16_bf16 v[112:127], v[148:151], a[20:23], v[112:127]
    buffer_load_dwordx4 v[148:151], v26, s[28:31], s59 offen
    s_add_u32 s59, s59, 1024
    s_cmp_eq_u32 s59, 22528
    s_cselect_b32 s59, 0, s59
    s_waitcnt lgkmcnt(0)
    ds_read_b64_tr_b16 a[184:185], v12 offset:22528
    ds_read_b64_tr_b16 a[186:187], v12 offset:23040
    ds_read_b64_tr_b16 a[188:189], v13 offset:22528
    ds_read_b64_tr_b16 a[190:191], v13 offset:23040
    s_waitcnt vmcnt(14)
    v_mfma_f32_32x32x16_bf16 v[64:79], v[152:155], a[24:27], v[64:79]
    v_mfma_f32_32x32x16_bf16 v[80:95], v[152:155], a[28:31], v[80:95]
    buffer_load_dwordx4 v[152:155], v25, s[28:31], s59 offen
    v_mfma_f32_32x32x16_bf16 v[96:111], v[156:159], a[24:27], v[96:111]
    v_mfma_f32_32x32x16_bf16 v[112:127], v[156:159], a[28:31], v[112:127]
    buffer_load_dwordx4 v[156:159], v26, s[28:31], s59 offen
    s_add_u32 s59, s59, 1024
    s_cmp_eq_u32 s59, 22528
    s_cselect_b32 s59, 0, s59
    s_waitcnt lgkmcnt(0)
    ds_read_b64_tr_b16 a[192:193], v12 offset:0
    ds_read_b64_tr_b16 a[194:195], v12 offset:512
    ds_read_b64_tr_b16 a[196:197], v13 offset:0
    ds_read_b64_tr_b16 a[198:199], v13 offset:512
    s_waitcnt vmcnt(14)
    v_mfma_f32_32x32x16_bf16 v[64:79], v[160:163], a[32:35], v[64:79]
    v_mfma_f32_32x32x16_bf16 v[80:95], v[160:163], a[36:39], v[80:95]
    buffer_load_dwordx4 v[160:163], v25, s[28:31], s59 offen
    v_mfma_f32_32x32x16_bf16 v[96:111], v[164:167], a[32:35], v[96:111]
    v_mfma_f32_32x32x16_bf16 v[112:127], v[164:167], a[36:39], v[112:127]
    buffer_load_dwordx4 v[164:167], v26, s[28:31], s59 offen
    s_add_u32 s59, s59, 1024
    s_cmp_eq_u32 s59, 22528
    s_cselect_b32 s59, 0, s59
    s_waitcnt lgkmcnt(0)
    ds_read_b64_tr_b16 a[200:201], v12 offset:2048
    ds_read_b64_tr_b16 a[202:203], v12 offset:2560
    ds_read_b64_tr_b16 a[204:205], v13 offset:2048
    ds_read_b64_tr_b16 a[206:207], v13 offset:2560
    s_waitcnt vmcnt(14)
    v_mfma_f32_32x32x16_bf16 v[64:79], v[168:171], a[40:43], v[64:79]
    v_mfma_f32_32x32x16_bf16 v[80:95], v[168:171], a[44:47], v[80:95]
    buffer_load_dwordx4 v[168:171], v25, s[28:31], s59 offen
    v_mfma_f32_32x32x16_bf16 v[96:111], v[172:175], a[40:43], v[96:111]
    v_mfma_f32_32x32x16_bf16 v[112:127], v[172:175], a[44:47], v[112:127]
    buffer_load_dwordx4 v[172:175], v26, s[28:31], s59 offen
    s_add_u32 s59, s59, 1024
    s_cmp_eq_u32 s59, 22528
    s_cselect_b32 s59, 0, s59
    s_waitcnt lgkmcnt(0)
    ds_read_b64_tr_b16 a[208:209], v12 offset:4096
    ds_read_b64_tr_b16 a[210:211], v12 offset:4608
    ds_read_b64_tr_b16 a[212:213], v13 offset:4096
    ds_read_b64_tr_b16 a[214:215], v13 offset:4608
    s_waitcnt vmcnt(14)
    v_mfma_f32_32x32x16_bf16 v[64:79], v[176:179], a[48:51], v[64:79]
    v_mfma_f32_32x32x16_bf16 v[80:95], v[176:179], a[52:55], v[80:95]
    buffer_load_dwordx4 v[176:179], v25, s[28:31], s59 offen
    v_mfma_f32_32x32x16_bf16 v[96:111], v[180:183], a[48:51], v[96:111]
    v_mfma_f32_32x32x16_bf16 v[112:127], v[180:183], a[52:55], v[112:127]
    buffer_load_dwordx4 v[180:183], v26, s[28:31], s59 offen
    s_add_u32 s59, s59, 1024
    s_cmp_eq_u32 s59, 22528
    s_cselect_b32 s59, 0, s59
    s_waitcnt lgkmcnt(0)
    ds_read_b64_tr_b16 a[216:217], v12 offset:6144
    ds_read_b64_tr_b16 a[218:219], v12 offset:6656
    ds_read_b64_tr_b16 a[220:221], v13 offset:6144
    ds_read_b64_tr_b16 a[222:223], v13 offset:6656
    s_waitcnt vmcnt(14)
    v_mfma_f32_32x32x16_bf16 v[64:79], v[184:187], a[56:59], v[64:79]
    v_mfma_f32_32x32x16_bf16 v[80:95], v[184:187], a[60:63], v[80:95]
    buffer_load_dwordx4 v[184:187], v25, s[28:31], s59 offen
    v_mfma_f32_32x32x16_bf16 v[96:111], v[188:191], a[56:59], v[96:111]
    v_mfma_f32_32x32x16_bf16 v[112:127], v[188:191], a[60:63], v[112:127]
    buffer_load_dwordx4 v[188:191], v26, s[28:31], s59 offen
    s_add_u32 s59, s59, 1024
    s_cmp_eq_u32 s59, 22528
    s_cselect_b32 s59, 0, s59
    s_waitcnt lgkmcnt(0)
    ds_read_b64_tr_b16 a[224:225], v12 offset:8192
    ds_read_b64_tr_b16 a[226:227], v12 offset:8704
    ds_read_b64_tr_b16 a[228:229], v13 offset:8192
    ds_read_b64_tr_b16 a[230:231], v13 offset:8704
    s_waitcnt vmcnt(14)
    v_mfma_f32_32x32x16_bf16 v[64:79], v[128:131], a[64:67], v[64:79]
    v_mfma_f32_32x32x16_bf16 v[80:95], v[128:131], a[68:71], v[80:95]
    buffer_load_dwordx4 v[128:131], v25, s[28:31], s59 offen
    v_mfma_f32_32x32x16_bf16 v[96:111], v[132:135], a[64:67], v[96:111]
    v_mfma_f32_32x32x16_bf16 v[112:127], v[132:135], a[68:71], v[112:127]
    buffer_load_dwordx4 v[132:135], v26, s[28:31], s59 offen
    s_add_u32 s59, s59, 1024
    s_cmp_eq_u32 s59, 22528
    s_cselect_b32 s59, 0, s59
    buffer_load_dwordx2 v[30:31], v21, s[28:31], 0 offen sc1
    s_waitcnt lgkmcnt(0)
    ds_read_b64_tr_b16 a[232:233], v12 offset:10240
    ds_read_b64_tr_b16 a[234:235], v12 offset:10752
    ds_read_b64_tr_b16 a[236:237], v13 offset:10240
    ds_read_b64_tr_b16 a[238:239], v13 offset:10752
    s_waitcnt vmcnt(15)
    v_mfma_f32_32x32x16_bf16 v[64:79], v[136:139], a[72:75], v[64:79]
    v_mfma_f32_32x32x16_bf16 v[80:95], v[136:139], a[76:79], v[80:95]
    buffer_load_dwordx4 v[136:139], v25, s[28:31], s59 offen
    v_mfma_f32_32x32x16_bf16 v[96:111], v[140:143], a[72:75], v[96:111]
    v_mfma_f32_32x32x16_bf16 v[112:127], v[140:143], a[76:79], v[112:127]
    buffer_load_dwordx4 v[140:143], v26, s[28:31], s59 offen
    s_add_u32 s59, s59, 1024
    s_cmp_eq_u32 s59, 22528
    s_cselect_b32 s59, 0, s59
    s_waitcnt lgkmcnt(0)
    s_waitcnt vmcnt(15)
    v_mfma_f32_32x32x16_bf16 v[64:79], v[144:147], a[80:83], v[64:79]
    v_mfma_f32_32x32x16_bf16 v[80:95], v[144:147], a[84:87], v[80:95]
    buffer_load_dwordx4 v[144:147], v25, s[28:31], s59 offen
    v_mfma_f32_32x32x16_bf16 v[96:111], v[148:151], a[80:83], v[96:111]
    v_mfma_f32_32x32x16_bf16 v[112:127], v[148:151], a[84:87], v[112:127]
    buffer_load_dwordx4 v[148:151], v26, s[28:31], s59 offen
    s_add_u32 s59, s59, 1024
    s_cmp_eq_u32 s59, 22528
    s_cselect_b32 s59, 0, s59
    s_waitcnt vmcnt(15)
    v_mfma_f32_32x32x16_bf16 v[64:79], v[152:155], a[88:91], v[64:79]
    v_mfma_f32_32x32x16_bf16 v[80:95], v[152:155], a[92:95], v[80:95]
    buffer_load_dwordx4 v[152:155], v25, s[28:31], s59 offen
    v_mfma_f32_32x32x16_bf16 v[96:111], v[156:159], a[88:91], v[96:111]
    v_mfma_f32_32x32x16_bf16 v[112:127], v[156:159], a[92:95], v[112:127]
    buffer_load_dwordx4 v[156:159], v26, s[28:31], s59 offen
    s_add_u32 s59, s59, 1024
    s_cmp_eq_u32 s59, 22528
    s_cselect_b32 s59, 0, s59
    s_waitcnt vmcnt(15)
    v_mfma_f32_32x32x16_bf16 v[64:79], v[160:163], a[96:99], v[64:79]
    v_mfma_f32_32x32x16_bf16 v[80:95], v[160:163], a[100:103], v[80:95]
    buffer_load_dwordx4 v[160:163], v25, s[28:31], s59 offen
    v_mfma_f32_32x32x16_bf16 v[96:111], v[164:167], a[96:99], v[96:111]
    v_mfma_f32_32x32x16_bf16 v[112:127], v[164:167], a[100:103], v[112:127]
    buffer_load_dwordx4 v[164:167], v26, s[28:31], s59 offen
    s_add_u32 s59, s59, 1024
    s_cmp_eq_u32 s59, 22528
    s_cselect_b32 s59, 0, s59
    s_waitcnt vmcnt(15)
    v_mfma_f32_32x32x16_bf16 v[64:79], v[168:171], a[104:107], v[64:79]
    v_mfma_f32_32x32x16_bf16 v[80:95], v[168:171], a[108:111], v[80:95]
    buffer_load_dwordx4 v[168:171], v25, s[28:31], s59 offen
    v_mfma_f32_32x32x16_bf16 v[96:111], v[172:175], a[104:107], v[96:111]
    v_mfma_f32_32x32x16_bf16 v[112:127], v[172:175], a[108:111], v[112:127]
    buffer_load_dwordx4 v[172:175], v26, s[28:31], s59 offen
    s_add_u32 s59, s59, 1024
    s_cmp_eq_u32 s59, 22528
    s_cselect_b32 s59, 0, s59
    s_waitcnt vmcnt(10)
    v_cmp_ne_u32 vcc, s74, v30
    v_cmp_ne_u32 s[50:51], s75, v31
    s_or_b64 vcc, vcc, s[50:51]
    s_cbranch_vccz Lok_25
    s_mov_b32 s48, 0
Lp_26:
    buffer_load_dwordx2 v[4:5], v21, s[28:31], 0 offen sc1
    s_add_u32 s48, s48, 1
    s_waitcnt vmcnt(0)
    v_cmp_ne_u32 vcc, s74, v4
    v_cmp_ne_u32 s[50:51], s75, v5
    s_or_b64 vcc, vcc, s[50:51]
    s_cbranch_vccz Ld_27
    s_cmp_lt_u32 s48, 200000
    s_cbranch_scc0 Ld_27
    s_sleep 1
    s_branch Lp_26
Ld_27:
Lok_25:
    v_mfma_f32_32x32x16_bf16 v[64:79], v[176:179], a[112:115], v[64:79]
    v_mfma_f32_32x32x16_bf16 v[80:95], v[176:179], a[116:119], v[80:95]
    buffer_load_dwordx4 v[176:179], v22, s[28:31], s53 offen
    v_mfma_f32_32x32x16_bf16 v[96:111], v[180:183], a[112:115], v[96:111]
    v_mfma_f32_32x32x16_bf16 v[112:127], v[180:183], a[116:119], v[112:127]
    buffer_load_dwordx4 v[180:183], v23, s[28:31], s53 offen
    s_add_u32 s53, s53, 1024
    s_and_b32 s53, s53, 0x1fff
    v_mfma_f32_32x32x16_bf16 v[64:79], v[184:187], a[120:123], v[64:79]
    v_mfma_f32_32x32x16_bf16 v[80:95], v[184:187], a[124:127], v[80:95]
    buffer_load_dwordx4 v[184:187], v22, s[28:31], s53 offen
    v_mfma_f32_32x32x16_bf16 v[96:111], v[188:191], a[120:123], v[96:111]
    v_mfma_f32_32x32x16_bf16 v[112:127], v[188:191], a[124:127], v[112:127]
    buffer_load_dwordx4 v[188:191], v23, s[28:31], s53 offen
    s_add_u32 s53, s53, 1024
    s_and_b32 s53, s53, 0x1fff
    v_mfma_f32_32x32x16_bf16 v[64:79], v[128:131], a[128:131], v[64:79]
    v_mfma_f32_32x32x16_bf16 v[80:95], v[128:131], a[132:135], v[80:95]
    buffer_load_dwordx4 v[128:131], v22, s[28:31], s53 offen
    v_mfma_f32_32x32x16_bf16 v[96:111], v[132:135], a[128:131], v[96:111]
    v_mfma_f32_32x32x16_bf16 v[112:127], v[132:135], a[132:135], v[112:127]
    buffer_load_dwordx4 v[132:135], v23, s[28:31], s53 offen
    s_add_u32 s53, s53, 1024
    s_and_b32 s53, s53, 0x1fff
    s_waitcnt vmcnt(14)
    v_mfma_f32_32x32x16_bf16 v[64:79], v[136:139], a[136:139], v[64:79]
    v_mfma_f32_32x32x16_bf16 v[80:95], v[136:139], a[140:143], v[80:95]
    buffer_load_dwordx4 v[136:139], v22, s[28:31], s53 offen
    v_mfma_f32_32x32x16_bf16 v[96:111], v[140:143], a[136:139], v[96:111]
    v_mfma_f32_32x32x16_bf16 v[112:127], v[140:143], a[140:143], v[112:127]
    buffer_load_dwordx4 v[140:143], v23, s[28:31], s53 offen
    s_add_u32 s53, s53, 1024
    s_and_b32 s53, s53, 0x1fff
    s_waitcnt vmcnt(14)
    v_mfma_f32_32x32x16_bf16 v[64:79], v[144:147], a[144:147], v[64:79]
    v_mfma_f32_32x32x16_bf16 v[80:95], v[144:147], a[148:151], v[80:95]
    buffer_load_dwordx4 v[144:147], v22, s[28:31], s53 offen
    v_mfma_f32_32x32x16_bf16 v[96:111], v[148:151], a[144:147], v[96:111]
    v_mfma_f32_32x32x16_bf16 v[112:127], v[148:151], a[148:151], v[112:127]
    buffer_load_dwordx4 v[148:151], v23, s[28:31], s53 offen
    s_add_u32 s53, s53, 1024
    s_and_b32 s53, s53, 0x1fff
    s_waitcnt vmcnt(14)
    v_mfma_f32_32x32x16_bf16 v[64:79], v[152:155], a[152:155], v[64:79]
    v_mfma_f32_32x32x16_bf16 v[80:95], v[152:155], a[156:159], v[80:95]
    buffer_load_dwordx4 v[152:155], v22, s[28:31], s53 offen
    v_mfma_f32_32x32x16_bf16 v[96:111], v[156:159], a[152:155], v[96:111]
    v_mfma_f32_32x32x16_bf16 v[112:127], v[156:159], a[156:159], v[112:127]
    buffer_load_dwordx4 v[156:159], v23, s[28:31], s53 offen
    s_add_u32 s53, s53, 1024
    s_and_b32 s53, s53, 0x1fff
    s_waitcnt vmcnt(14)
    v_mfma_f32_32x32x16_bf16 v[64:79], v[160:163], a[160:163], v[64:79]
    v_mfma_f32_32x32x16_bf16 v[80:95], v[160:163], a[164:167], v[80:95]
    buffer_load_dwordx4 v[160:163], v22, s[28:31], s53 offen
    v_mfma_f32_32x32x16_bf16 v[96:111], v[164:167], a[160:163], v[96:111]
    v_mfma_f32_32x32x16_bf16 v[112:127], v[164:167], a[164:167], v[112:127]
    buffer_load_dwordx4 v[164:167], v23, s[28:31], s53 offen
    s_add_u32 s53, s53, 1024
    s_and_b32 s53, s53, 0x1fff
    s_waitcnt vmcnt(14)
    v_mfma_f32_32x32x16_bf16 v[64:79], v[168:171], a[168:171], v[64:79]
    v_mfma_f32_32x32x16_bf16 v[80:95], v[168:171], a[172:175], v[80:95]
    buffer_load_dwordx4 v[168:171], v22, s[28:31], s53 offen
    v_mfma_f32_32x32x16_bf16 v[96:111], v[172:175], a[168:171], v[96:111]
    v_mfma_f32_32x32x16_bf16 v[112:127], v[172:175], a[172:175], v[112:127]
    buffer_load_dwordx4 v[172:175], v23, s[28:31], s53 offen
    s_add_u32 s53, s53, 1024
    s_and_b32 s53, s53, 0x1fff
    s_waitcnt vmcnt(14)
    v_mfma_f32_32x32x16_bf16 v[64:79], a[176:179], v[176:179], v[64:79]
    v_mfma_f32_32x32x16_bf16 v[80:95], a[176:179], v[180:183], v[80:95]
    v_mfma_f32_32x32x16_bf16 v[96:111], a[180:183], v[176:179], v[96:111]
    v_mfma_f32_32x32x16_bf16 v[112:127], a[180:183], v[180:183], v[112:127]
    s_waitcnt vmcnt(12)
    v_mfma_f32_32x32x16_bf16 v[64:79], a[184:187], v[184:187], v[64:79]
    v_mfma_f32_32x32x16_bf16 v[80:95], a[184:187], v[188:191], v[80:95]
    v_mfma_f32_32x32x16_bf16 v[96:111], a[188:191], v[184:187], v[96:111]
    v_mfma_f32_32x32x16_bf16 v[112:127], a[188:191], v[188:191], v[112:127]
    s_waitcnt vmcnt(10)
    v_mfma_f32_32x32x16_bf16 v[64:79], a[192:195], v[128:131], v[64:79]
    v_mfma_f32_32x32x16_bf16 v[80:95], a[192:195], v[132:135], v[80:95]
    v_mfma_f32_32x32x16_bf16 v[96:111], a[196:199], v[128:131], v[96:111]
    v_mfma_f32_32x32x16_bf16 v[112:127], a[196:199], v[132:135], v[112:127]
    s_waitcnt vmcnt(8)
    v_mfma_f32_32x32x16_bf16 v[64:79], a[200:203], v[136:139], v[64:79]
    v_mfma_f32_32x32x16_bf16 v[80:95], a[200:203], v[140:143], v[80:95]
    v_mfma_f32_32x32x16_bf16 v[96:111], a[204:207], v[136:139], v[96:111]
    v_mfma_f32_32x32x16_bf16 v[112:127], a[204:207], v[140:143], v[112:127]
    s_waitcnt vmcnt(6)
    v_mfma_f32_32x32x16_bf16 v[64:79], a[208:211], v[144:147], v[64:79]
    v_mfma_f32_32x32x16_bf16 v[80:95], a[208:211], v[148:151], v[80:95]
    v_mfma_f32_32x32x16_bf16 v[96:111], a[212:215], v[144:147], v[96:111]
    v_mfma_f32_32x32x16_bf16 v[112:127], a[212:215], v[148:151], v[112:127]
    s_waitcnt vmcnt(4)
    v_mfma_f32_32x32x16_bf16 v[64:79], a[216:219], v[152:155], v[64:79]
    v_mfma_f32_32x32x16_bf16 v[80:95], a[216:219], v[156:159], v[80:95]
    v_mfma_f32_32x32x16_bf16 v[96:111], a[220:223], v[152:155], v[96:111]
    v_mfma_f32_32x32x16_bf16 v[112:127], a[220:223], v[156:159], v[112:127]
    s_waitcnt vmcnt(2)
    v_mfma_f32_32x32x16_bf16 v[64:79], a[224:227], v[160:163], v[64:79]
    v_mfma_f32_32x32x16_bf16 v[80:95], a[224:227], v[164:167], v[80:95]
    v_mfma_f32_32x32x16_bf16 v[96:111], a[228:231], v[160:163], v[96:111]
    v_mfma_f32_32x32x16_bf16 v[112:127], a[228:231], v[164:167], v[112:127]
    s_waitcnt vmcnt(0)
    v_mfma_f32_32x32x16_bf16 v[64:79], a[232:235], v[168:171], v[64:79]
    v_mfma_f32_32x32x16_bf16 v[80:95], a[232:235], v[172:175], v[80:95]
    v_mfma_f32_32x32x16_bf16 v[96:111], a[236:239], v[168:171], v[96:111]
    v_mfma_f32_32x32x16_bf16 v[112:127], a[236:239], v[172:175], v[112:127]
    s_barrier
    s_mul_i32 s48, s26, 12288
    s_add_u32 s48, s48, 98304
    v_add_u32 v14, s48, v11
    s_xor_b32 s48, s26, 1
    s_mul_i32 s48, s48, 12288
    s_add_u32 s48, s48, 98304
    v_add_u32 v15, s48, v11
    s_xor_b32 s48, s26, 2
    s_mul_i32 s48, s48, 12288
    s_add_u32 s48, s48, 102400
    v_add_u32 v16, s48, v11
    s_xor_b32 s48, s26, 3
    s_mul_i32 s48, s48, 12288
    s_add_u32 s48, s48, 106496
    v_add_u32 v17, s48, v11
    s_nop 7
    ds_write_b128 v14, v[80:83] offset:0
    ds_write_b128 v14, v[84:87] offset:1024
    ds_write_b128 v14, v[88:91] offset:2048
    ds_write_b128 v14, v[92:95] offset:3072
    ds_write_b128 v14, v[96:99] offset:4096
    ds_write_b128 v14, v[100:103] offset:5120
    ds_write_b128 v14, v[104:107] offset:6144
    ds_write_b128 v14, v[108:111] offset:7168
    s_nop 3
    ds_write_b128 v14, v[112:115] offset:8192
    ds_write_b128 v14, v[116:119] offset:9216
    ds_write_b128 v14, v[120:123] offset:10240
    ds_write_b128 v14, v[124:127] offset:11264
    s_waitcnt lgkmcnt(0)
    s_barrier
    ds_read_b128 v[128:131], v15 offset:0
    ds_read_b128 v[132:135], v15 offset:1024
    ds_read_b128 v[136:139], v15 offset:2048
    ds_read_b128 v[140:143], v15 offset:3072
    ds_read_b128 v[144:147], v16 offset:0
    ds_read_b128 v[148:151], v16 offset:1024
    ds_read_b128 v[152:155], v16 offset:2048
    ds_read_b128 v[156:159], v16 offset:3072
    ds_read_b128 v[160:163], v17 offset:0
    ds_read_b128 v[164:167], v17 offset:1024
    ds_read_b128 v[168:171], v17 offset:2048
    ds_read_b128 v[172:175], v17 offset:3072
    s_waitcnt lgkmcnt(8)
    v_pk_add_f32 v[64:65], v[64:65], v[128:129]
    v_pk_add_f32 v[66:67], v[66:67], v[130:131]
    v_pk_add_f32 v[68:69], v[68:69], v[132:133]
    v_pk_add_f32 v[70:71], v[70:71], v[134:135]
    v_pk_add_f32 v[72:73], v[72:73], v[136:137]
    v_pk_add_f32 v[74:75], v[74:75], v[138:139]
    v_pk_add_f32 v[76:77], v[76:77], v[140:141]
    v_pk_add_f32 v[78:79], v[78:79], v[142:143]
    s_waitcnt lgkmcnt(4)
    v_pk_add_f32 v[64:65], v[64:65], v[144:145]
    v_pk_add_f32 v[66:67], v[66:67], v[146:147]
    v_pk_add_f32 v[68:69], v[68:69], v[148:149]
    v_pk_add_f32 v[70:71], v[70:71], v[150:151]
    v_pk_add_f32 v[72:73], v[72:73], v[152:153]
    v_pk_add_f32 v[74:75], v[74:75], v[154:155]
    v_pk_add_f32 v[76:77], v[76:77], v[156:157]
    v_pk_add_f32 v[78:79], v[78:79], v[158:159]
    s_waitcnt lgkmcnt(0)
    v_pk_add_f32 v[64:65], v[64:65], v[160:161]
    v_pk_add_f32 v[66:67], v[66:67], v[162:163]
    v_pk_add_f32 v[68:69], v[68:69], v[164:165]
    v_pk_add_f32 v[70:71], v[70:71], v[166:167]
    v_pk_add_f32 v[72:73], v[72:73], v[168:169]
    v_pk_add_f32 v[74:75], v[74:75], v[170:171]
    v_pk_add_f32 v[76:77], v[76:77], v[172:173]
    v_pk_add_f32 v[78:79], v[78:79], v[174:175]
    s_mov_b32 s32, s20
    s_and_b32 s33, s21, 0xffff
    s_mov_b32 s34, 0x200000
    s_mov_b32 s35, 0x20000
    v_lshlrev_b32 v48, 16, v48
    v_lshlrev_b32 v128, 16, v40
    v_and_b32 v129, 0xffff0000, v40
    v_lshlrev_b32 v130, 16, v41
    v_and_b32 v131, 0xffff0000, v41
    v_lshlrev_b32 v132, 16, v42
    v_and_b32 v133, 0xffff0000, v42
    v_lshlrev_b32 v134, 16, v43
    v_and_b32 v135, 0xffff0000, v43
    v_lshlrev_b32 v136, 16, v44
    v_and_b32 v137, 0xffff0000, v44
    v_lshlrev_b32 v138, 16, v45
    v_and_b32 v139, 0xffff0000, v45
    v_lshlrev_b32 v140, 16, v46
    v_and_b32 v141, 0xffff0000, v46
    v_lshlrev_b32 v142, 16, v47
    v_and_b32 v143, 0xffff0000, v47
    v_pk_add_f32 v[64:65], v[64:65], v[128:129]
    v_pk_add_f32 v[64:65], v[64:65], v[48:49] op_sel_hi:[1,0]
    v_pk_add_f32 v[66:67], v[66:67], v[130:131]
    v_pk_add_f32 v[66:67], v[66:67], v[48:49] op_sel_hi:[1,0]
    v_pk_add_f32 v[68:69], v[68:69], v[132:133]
    v_pk_add_f32 v[68:69], v[68:69], v[48:49] op_sel_hi:[1,0]
    v_pk_add_f32 v[70:71], v[70:71], v[134:135]
    v_pk_add_f32 v[70:71], v[70:71], v[48:49] op_sel_hi:[1,0]
    v_pk_add_f32 v[72:73], v[72:73], v[136:137]
    v_pk_add_f32 v[72:73], v[72:73], v[48:49] op_sel_hi:[1,0]
    v_pk_add_f32 v[74:75], v[74:75], v[138:139]
    v_pk_add_f32 v[74:75], v[74:75], v[48:49] op_sel_hi:[1,0]
    v_pk_add_f32 v[76:77], v[76:77], v[140:141]
    v_pk_add_f32 v[76:77], v[76:77], v[48:49] op_sel_hi:[1,0]
    v_pk_add_f32 v[78:79], v[78:79], v[142:143]
    v_pk_add_f32 v[78:79], v[78:79], v[48:49] op_sel_hi:[1,0]
    v_cvt_pk_bf16_f32 v128, v64, v65
    v_cvt_pk_bf16_f32 v129, v66, v67
    v_cvt_pk_bf16_f32 v130, v68, v69
    v_cvt_pk_bf16_f32 v131, v70, v71
    v_cvt_pk_bf16_f32 v132, v72, v73
    v_cvt_pk_bf16_f32 v133, v74, v75
    v_cvt_pk_bf16_f32 v134, v76, v77
    v_cvt_pk_bf16_f32 v135, v78, v79
    buffer_store_dwordx2 v[128:129], v8, s[32:35], s71 offen offset:0
    buffer_store_dwordx2 v[130:131], v8, s[32:35], s71 offen offset:16
    buffer_store_dwordx2 v[132:133], v8, s[32:35], s71 offen offset:32
    buffer_store_dwordx2 v[134:135], v8, s[32:35], s71 offen offset:48
L_flush:
L_exit:
    s_endpgm
Lcode_end:

.section .rodata,"a"
.p2align 6
.amdhsa_kernel parallel_sum__sliding_local_dilated__mixer_token_mlp__prompt_kernel
  .amdhsa_next_free_vgpr 512
  .amdhsa_next_free_sgpr 102
  .amdhsa_accum_offset 256
  .amdhsa_group_segment_fixed_size 0
  .amdhsa_kernarg_size 88
  .amdhsa_user_sgpr_count 2
  .amdhsa_user_sgpr_kernarg_segment_ptr 1
  .amdhsa_system_sgpr_workgroup_id_x 1
  .amdhsa_float_denorm_mode_32 3
.end_amdhsa_kernel
```
